```python
import torch

def _softmax(x, axis=-1):
    return torch.softmax(x, dim=axis)
def _gelu(x):
    return torch.nn.functional.gelu(x, approximate="tanh")
def _silu(x):
    return torch.nn.functional.silu(x)
def _sigmoid(x):
    return torch.sigmoid(x)
def _layernorm(x, axis=-1, eps=1e-5):
    m = x.mean(dim=axis, keepdim=True)
    v = x.var(dim=axis, keepdim=True, unbiased=False)
    return (x - m) / torch.sqrt(v + eps)
def _scatter_add(tgt, idx, src, axis=0):
    return tgt.clone().index_add_(axis, idx, src)
def _segment_sum(src, seg, n):
    out = torch.zeros((n,) + src.shape[1:], dtype=src.dtype)
    return out.index_add_(0, seg, src)
def _pad(x, pw):
    flat = tuple(v for pair in reversed(pw) for v in pair)
    return torch.nn.functional.pad(x, flat)

kernel_name = 'concat_heads__compressed_kv_cla__gqa_block_cached__decode'

def setup_inputs():

    _w = (lambda a: (lambda t: t.to(torch.bfloat16) if t.is_floating_point() else t)(torch.as_tensor(a)))
    def _A_setup():
        B, H, Sq, Sk, D, M = 2, 32, 1, 8192, 128, 512
        Dc = 4 * D
        return {
            "x": _w((lambda *s: torch.randn(*s, dtype=torch.bfloat16) * 3.2)(B, Sq, M)),
            "c_kv": _w((lambda *s: torch.randn(*s, dtype=torch.bfloat16) * 0.1)(B, Sk, Dc)),
            "w_q": _w((lambda *s: torch.randn(*s, dtype=torch.bfloat16) * 6.4)(M, H, D) * (M ** -0.5)),
            "w_uk": _w((lambda *s: torch.randn(*s, dtype=torch.bfloat16) * 6.4)(Dc, H, D) * (Dc ** -0.5)),
            "w_uv": _w((lambda *s: torch.randn(*s, dtype=torch.bfloat16) * 0.1)(Dc, H, D) * (Dc ** -0.5)),
            "w_o": _w((lambda *s: torch.randn(*s, dtype=torch.bfloat16) * 0.1)(H, D, M) * ((H * D) ** -0.5)),
        }
    _A_in = _A_setup()

    def _B_setup():
        B, Sq, D = 2, 1, 512
        Hq, Hkv, Sk, Dh = 32, 8, 8192, 128
        assert Hq % Hkv == 0, (Hq, Hkv)
        return {
            "x": _w((lambda *s: torch.randn(*s, dtype=torch.bfloat16) * 1.6)(B, Sq, D)),
            "k_cache": _w((lambda *s: torch.randn(*s, dtype=torch.bfloat16) * 1.6)(B, Hkv, Sk, Dh)),
            "v_cache": _w((lambda *s: torch.randn(*s, dtype=torch.bfloat16) * 0.05)(B, Hkv, Sk, Dh)),
            "wq": _w((lambda *s: torch.randn(*s, dtype=torch.bfloat16) * 1.6)(D, Hq * Dh) * (D ** -0.5)),
            "wo": _w((lambda *s: torch.randn(*s, dtype=torch.bfloat16) * 0.05)(Hq * Dh, D) * ((Hq * Dh) ** -0.5)),
        }
    _B_in = _B_setup()

    return {
        "A_x": _A_in["x"],
        "A_c_kv": _A_in["c_kv"],
        "A_w_q": _A_in["w_q"],
        "A_w_uk": _A_in["w_uk"],
        "A_w_uv": _A_in["w_uv"],
        "A_w_o": _A_in["w_o"],
        "B_x": _B_in["x"],
        "B_k_cache": _B_in["k_cache"],
        "B_v_cache": _B_in["v_cache"],
        "B_wq": _B_in["wq"],
        "B_wo": _B_in["wo"],
    }

def reference(A_x, A_c_kv, A_w_q, A_w_uk, A_w_uv, A_w_o, B_x, B_k_cache, B_v_cache, B_wq, B_wo):
    def _A_ref(x, c_kv, w_q, w_uk, w_uv, w_o):
        B, Sq, M = x.shape[0], x.shape[1], x.shape[2]
        Sk = c_kv.shape[1]
        H, D = w_q.shape[1], w_q.shape[2]
        q = torch.einsum("bqm,mhd->bhqd", x, w_q)
        k = torch.einsum("bkc,chd->bhkd", c_kv, w_uk)
        v = torch.einsum("bkc,chd->bhkd", c_kv, w_uv)
        scores = torch.einsum("bhqd,bhkd->bhqk", q, k) * (D ** -0.5)
        off = Sk - Sq
        qi = torch.arange(Sq)[:, None]
        kj = torch.arange(Sk)[None, :]
        cmask = kj <= (qi + off)
        scores = torch.where(cmask[None, None], scores, -1e9)
        p = _softmax(scores, axis=-1)
        ctx = torch.einsum("bhqk,bhkd->bhqd", p, v)
        return torch.einsum("bhqd,hdm->bqm", ctx, w_o)

    def _B_ref(x, k_cache, v_cache, wq, wo):
        B, Sq, D = x.shape
        Hq, Dh = 32, 128
        Hkv = k_cache.shape[1]
        rep = Hq // Hkv
        q = (lambda x, *d: x.permute(*d))((x @ wq).reshape(B, Sq, Hq, Dh), 0, 2, 1, 3)
        k = (lambda x, n, axis: torch.repeat_interleave(x, n, dim=axis))(k_cache, rep, axis=1)
        v = (lambda x, n, axis: torch.repeat_interleave(x, n, dim=axis))(v_cache, rep, axis=1)
        scores = torch.einsum("bhqd,bhkd->bhqk", q, k) * (Dh ** -0.5)
        p = _softmax(scores, axis=-1)
        o = torch.einsum("bhqk,bhkd->bhqd", p, v)
        return (lambda x, *d: x.permute(*d))(o, 0, 2, 1, 3).reshape(B, Sq, Hq * Dh) @ wo

    a = _A_ref(A_x, A_c_kv, A_w_q, A_w_uk, A_w_uv, A_w_o)
    b = _B_ref(B_x, B_k_cache, B_v_cache, B_wq, B_wo)
    return torch.concatenate([a, b], axis=-1)
```

```asm
; @launch grid=(256,1,1) block=(512,1,1) lds=163840
.amdgcn_target "amdgcn-amd-amdhsa--gfx950"
.text
.globl concat_heads__compressed_kv_cla__gqa_block_cached__decode_kernel
.p2align 8
.type concat_heads__compressed_kv_cla__gqa_block_cached__decode_kernel,@function
concat_heads__compressed_kv_cla__gqa_block_cached__decode_kernel:
    s_cmp_ge_u32 s2, 256
    s_cbranch_scc1 L_end
    s_load_dwordx16 s[4:19], s[0:1], 0
    s_load_dwordx8 s[20:27], s[0:1], 64
    s_load_dwordx4 s[28:31], s[0:1], 96
    v_lshrrev_b32 v4, 6, v0
    v_and_b32 v0, 63, v0
    v_readfirstlane_b32 s3, v4
    v_and_b32 v1, 15, v0
    v_lshrrev_b32 v2, 4, v0
    s_cmp_ge_u32 s2, 96
    s_cbranch_scc1 L_roleB
    s_cmp_ge_u32 s2, 32
    s_cbranch_scc1 L_roleA
L_roleT:
    s_and_b32 s101, s2, 7
    s_lshl_b32 s101, s101, 4
    s_lshr_b32 s63, s2, 3
    s_and_b32 s63, s63, 3
    s_add_u32 s101, s101, s63
    s_add_u32 s100, s101, 0
    s_add_u32 s101, s101, 136
    v_lshlrev_b32 v4, 15, v2
    v_lshl_add_u32 v4, v1, 4, v4
    v_bfe_u32 v5, v1, 2, 1
    v_lshlrev_b32 v5, 10, v5
    v_lshl_add_u32 v5, v2, 3, v5
    s_and_b32 s62, s100, 3
    s_lshl_b32 s62, s62, 7
    s_lshl_b32 s63, s3, 4
    s_add_u32 s62, s62, s63
    s_lshl_b32 s40, s62, 13
    s_lshr_b32 s63, s100, 2
    s_and_b32 s63, s63, 31
    s_lshl_b32 s63, s63, 8
    s_add_u32 s40, s40, s63
    s_lshl_b32 s62, s62, 1
    s_waitcnt lgkmcnt(0)
    s_add_u32 s40, s8, s40
    s_addc_u32 s41, s9, 0
    s_add_u32 s42, s4, s62
    s_addc_u32 s43, s5, 0
    global_load_dwordx2 v[8:9], v5, s[42:43]
    global_load_dwordx4 v[16:19], v4, s[40:41] offset:0 nt
    s_add_u32 s40, s40, 8192
    s_addc_u32 s41, s41, 0
    global_load_dwordx4 v[20:23], v4, s[40:41] offset:0 nt
    s_add_u32 s40, s40, 8192
    s_addc_u32 s41, s41, 0
    global_load_dwordx4 v[24:27], v4, s[40:41] offset:0 nt
    s_add_u32 s40, s40, 8192
    s_addc_u32 s41, s41, 0
    global_load_dwordx4 v[28:31], v4, s[40:41] offset:0 nt
    s_barrier
    s_and_b32 s62, s101, 3
    s_lshl_b32 s62, s62, 7
    s_lshl_b32 s63, s3, 4
    s_add_u32 s62, s62, s63
    s_lshl_b32 s40, s62, 13
    s_lshr_b32 s63, s101, 2
    s_and_b32 s63, s63, 31
    s_lshl_b32 s63, s63, 8
    s_add_u32 s40, s40, s63
    s_lshl_b32 s62, s62, 1
    s_add_u32 s40, s22, s40
    s_addc_u32 s41, s23, 0
    s_add_u32 s42, s16, s62
    s_addc_u32 s43, s17, 0
    global_load_dwordx2 v[10:11], v5, s[42:43]
    global_load_dwordx4 v[32:35], v4, s[40:41] offset:0 nt
    s_add_u32 s40, s40, 8192
    s_addc_u32 s41, s41, 0
    global_load_dwordx4 v[36:39], v4, s[40:41] offset:0 nt
    s_add_u32 s40, s40, 8192
    s_addc_u32 s41, s41, 0
    global_load_dwordx4 v[40:43], v4, s[40:41] offset:0 nt
    s_add_u32 s40, s40, 8192
    s_addc_u32 s41, s41, 0
    global_load_dwordx4 v[44:47], v4, s[40:41] offset:0 nt
    s_load_dword s32, s[30:31], 0
    s_mov_b32 s34, 0x7060500
    s_mov_b32 s35, 0x7060501
    s_mov_b32 s36, 0x7060502
    s_mov_b32 s37, 0x7060503
    s_mov_b32 s38, 0x05040100
    s_mov_b32 s39, 0x07060302
    s_mov_b32 s48, 0x0c0c0400
    s_mov_b32 s51, 0x3e0293ee
    s_mov_b32 s96, 0x55555555
    s_mov_b32 s97, 0x55555555
    s_cmp_eq_u32 s3, 1
    s_cbranch_scc0 L_skip_1
    s_and_b32 s62, s2, 7
    s_lshl_b32 s62, s62, 7
    s_lshr_b32 s63, s2, 3
    s_lshl_b32 s63, s63, 2
    s_add_u32 s62, s62, s63
    s_add_u32 s60, s30, s62
    s_addc_u32 s61, s31, 0
    s_add_u32 s60, s60, 638976
    s_addc_u32 s61, s61, 0
    s_waitcnt lgkmcnt(0)
    s_add_u32 s90, s32, 0x01010101
    s_getreg_b32 s62, hwreg(HW_REG_XCC_ID)
    s_and_b32 s62, s62, 15
    s_and_b32 s90, s90, -16
    s_or_b32 s90, s90, s62
    v_mov_b32 v246, 0
    v_mov_b32 v247, s90
    s_mov_b32 exec_lo, 0x1
    s_mov_b32 exec_hi, 0x0
    global_store_dword v246, v247, s[60:61]
    s_mov_b64 exec, -1
L_skip_1:
    s_mov_b32 s90, 0
    s_and_b32 s62, s2, 7
    s_lshl_b32 s62, s62, 2
    s_lshr_b32 s63, s2, 3
    s_and_b32 s63, s63, 3
    s_add_u32 s62, s62, s63
    s_mov_b32 s2, s62
    v_lshlrev_b32 v160, 13, v2
    v_lshl_add_u32 v160, v1, 4, v160
    v_mov_b32 v164, 0
    v_mov_b32 v165, 0
    v_mov_b32 v166, 0
    v_mov_b32 v167, 0
    v_mov_b32 v161, 16384
    ds_write_b128 v161, v[164:167]
    ds_write_b128 v161, v[164:167] offset:13312
    v_lshlrev_b32 v4, 5, v1
    v_lshl_add_u32 v4, v2, 9, v4
    s_lshl_b32 s62, s3, 10
    v_add_u32 v4, s62, v4
    s_lshr_b32 s90, s100, 4
    s_cmp_eq_u32 s3, 7
    s_cbranch_scc0 L_skip_2
    s_and_b32 s62, s90, 7
    s_lshl_b32 s62, s62, 7
    s_add_u32 s60, s30, s62
    s_addc_u32 s61, s31, 0
    s_add_u32 s60, s60, 638976
    s_addc_u32 s61, s61, 0
    v_and_b32 v245, 31, v0
    v_lshlrev_b32 v245, 2, v245
    global_load_dword v245, v245, s[60:61] sc1
L_skip_2:
    s_mov_b32 s90, 0
    s_waitcnt vmcnt(5)
    v_perm_b32 v48, v20, v16, s38
    v_perm_b32 v49, v28, v24, s38
    s_nop 1
    v_mfma_f32_16x16x16_bf16 v[64:67], v[8:9], v[48:49], 0
    v_perm_b32 v50, v20, v16, s39
    v_perm_b32 v51, v28, v24, s39
    s_nop 1
    v_mfma_f32_16x16x16_bf16 v[68:71], v[8:9], v[50:51], 0
    v_perm_b32 v52, v21, v17, s38
    v_perm_b32 v53, v29, v25, s38
    s_nop 1
    v_mfma_f32_16x16x16_bf16 v[72:75], v[8:9], v[52:53], 0
    v_perm_b32 v54, v21, v17, s39
    v_perm_b32 v55, v29, v25, s39
    s_nop 1
    v_mfma_f32_16x16x16_bf16 v[76:79], v[8:9], v[54:55], 0
    v_perm_b32 v48, v22, v18, s38
    v_perm_b32 v49, v30, v26, s38
    s_nop 1
    v_mfma_f32_16x16x16_bf16 v[80:83], v[8:9], v[48:49], 0
    v_perm_b32 v50, v22, v18, s39
    v_perm_b32 v51, v30, v26, s39
    s_nop 1
    v_mfma_f32_16x16x16_bf16 v[84:87], v[8:9], v[50:51], 0
    v_perm_b32 v52, v23, v19, s38
    v_perm_b32 v53, v31, v27, s38
    s_nop 1
    v_mfma_f32_16x16x16_bf16 v[88:91], v[8:9], v[52:53], 0
    v_perm_b32 v54, v23, v19, s39
    v_perm_b32 v55, v31, v27, s39
    s_nop 1
    v_mfma_f32_16x16x16_bf16 v[92:95], v[8:9], v[54:55], 0
    s_mov_b32 exec_lo, 0xffffffff
    s_mov_b32 exec_hi, 0x0
    ds_write2_b32 v4, v64, v68 offset0:0 offset1:1
    ds_write2_b32 v4, v72, v76 offset0:2 offset1:3
    ds_write2_b32 v4, v80, v84 offset0:4 offset1:5
    s_nop 2
    ds_write2_b32 v4, v88, v92 offset0:6 offset1:7
    s_mov_b64 exec, -1
    s_waitcnt lgkmcnt(0)
    s_add_u32 s33, s32, 0x01010101
    v_mov_b32 v3, s33
    s_lshr_b32 s49, s33, 16
    s_and_b32 s49, s49, 0xff00
    s_and_b32 s50, s33, 0xff
    s_or_b32 s49, s49, s50
    s_mov_b32 s50, 0xffffff00
    s_getreg_b32 s62, hwreg(HW_REG_XCC_ID)
    s_and_b32 s62, s62, 15
    s_and_b32 s33, s33, -16
    s_or_b32 s33, s33, s62
    s_barrier
    s_cmp_eq_u32 s3, 7
    s_cbranch_scc0 L_skip_3
    v_lshlrev_b32 v4, 4, v0
    ds_read_b128 v[64:67], v4 offset:0
    ds_read_b128 v[68:71], v4 offset:1024
    ds_read_b128 v[72:75], v4 offset:2048
    ds_read_b128 v[76:79], v4 offset:3072
    ds_read_b128 v[80:83], v4 offset:4096
    ds_read_b128 v[84:87], v4 offset:5120
    ds_read_b128 v[88:91], v4 offset:6144
    ds_read_b128 v[92:95], v4 offset:7168
    s_lshl_b32 s62, s100, 10
    s_add_u32 s42, s30, s62
    s_addc_u32 s43, s31, 0
    s_add_u32 s42, s42, 65536
    s_addc_u32 s43, s43, 0
    s_waitcnt lgkmcnt(0)
    v_add_f32 v64, v64, v80
    v_add_f32 v65, v65, v81
    v_add_f32 v66, v66, v82
    v_add_f32 v67, v67, v83
    v_add_f32 v68, v68, v84
    v_add_f32 v69, v69, v85
    v_add_f32 v70, v70, v86
    v_add_f32 v71, v71, v87
    v_add_f32 v72, v72, v88
    v_add_f32 v73, v73, v89
    v_add_f32 v74, v74, v90
    v_add_f32 v75, v75, v91
    v_add_f32 v76, v76, v92
    v_add_f32 v77, v77, v93
    v_add_f32 v78, v78, v94
    v_add_f32 v79, v79, v95
    v_add_f32 v64, v64, v72
    v_add_f32 v65, v65, v73
    v_add_f32 v66, v66, v74
    v_add_f32 v67, v67, v75
    v_add_f32 v68, v68, v76
    v_add_f32 v69, v69, v77
    v_add_f32 v70, v70, v78
    v_add_f32 v71, v71, v79
    v_add_f32 v64, v64, v68
    v_add_f32 v65, v65, v69
    v_add_f32 v66, v66, v70
    v_add_f32 v67, v67, v71
    v_perm_b32 v64, v64, v3, s34
    v_perm_b32 v65, v65, v3, s35
    v_perm_b32 v66, v66, v3, s36
    v_perm_b32 v67, v67, v3, s37
    s_waitcnt vmcnt(0)
    v_cmp_ne_u32 s[60:61], s33, v245
    s_nop 0
    s_cmp_eq_u64 s[60:61], 0
    s_cselect_b32 s90, 1, 0
    s_cmp_lg_u32 s90, 0
    s_cbranch_scc1 L_sl_4
    global_store_dwordx4 v4, v[64:67], s[42:43] sc1
    s_branch L_sd_5
L_sl_4:
    global_store_dwordx4 v4, v[64:67], s[42:43]
L_sd_5:
L_skip_3:
    v_lshlrev_b32 v4, 5, v1
    v_lshl_add_u32 v4, v2, 9, v4
    s_lshl_b32 s62, s3, 10
    s_add_u32 s62, s62, 8192
    v_add_u32 v4, s62, v4
    s_waitcnt vmcnt(0)
    v_perm_b32 v48, v36, v32, s38
    v_perm_b32 v49, v44, v40, s38
    s_nop 1
    v_mfma_f32_16x16x16_bf16 v[64:67], v[10:11], v[48:49], 0
    v_perm_b32 v50, v36, v32, s39
    v_perm_b32 v51, v44, v40, s39
    s_nop 1
    v_mfma_f32_16x16x16_bf16 v[68:71], v[10:11], v[50:51], 0
    v_perm_b32 v52, v37, v33, s38
    v_perm_b32 v53, v45, v41, s38
    s_nop 1
    v_mfma_f32_16x16x16_bf16 v[72:75], v[10:11], v[52:53], 0
    v_perm_b32 v54, v37, v33, s39
    v_perm_b32 v55, v45, v41, s39
    s_nop 1
    v_mfma_f32_16x16x16_bf16 v[76:79], v[10:11], v[54:55], 0
    v_perm_b32 v48, v38, v34, s38
    v_perm_b32 v49, v46, v42, s38
    s_nop 1
    v_mfma_f32_16x16x16_bf16 v[80:83], v[10:11], v[48:49], 0
    v_perm_b32 v50, v38, v34, s39
    v_perm_b32 v51, v46, v42, s39
    s_nop 1
    v_mfma_f32_16x16x16_bf16 v[84:87], v[10:11], v[50:51], 0
    v_perm_b32 v52, v39, v35, s38
    v_perm_b32 v53, v47, v43, s38
    s_nop 1
    v_mfma_f32_16x16x16_bf16 v[88:91], v[10:11], v[52:53], 0
    v_perm_b32 v54, v39, v35, s39
    v_perm_b32 v55, v47, v43, s39
    s_nop 1
    v_mfma_f32_16x16x16_bf16 v[92:95], v[10:11], v[54:55], 0
    s_mov_b32 exec_lo, 0xffffffff
    s_mov_b32 exec_hi, 0x0
    ds_write2_b32 v4, v64, v68 offset0:0 offset1:1
    ds_write2_b32 v4, v72, v76 offset0:2 offset1:3
    ds_write2_b32 v4, v80, v84 offset0:4 offset1:5
    s_nop 2
    ds_write2_b32 v4, v88, v92 offset0:6 offset1:7
    s_mov_b64 exec, -1
    s_waitcnt lgkmcnt(0)
    s_barrier
    s_cmp_eq_u32 s3, 7
    s_cbranch_scc0 L_skip_6
    v_lshlrev_b32 v4, 4, v0
    ds_read_b128 v[64:67], v4 offset:8192
    ds_read_b128 v[68:71], v4 offset:9216
    ds_read_b128 v[72:75], v4 offset:10240
    ds_read_b128 v[76:79], v4 offset:11264
    ds_read_b128 v[80:83], v4 offset:12288
    ds_read_b128 v[84:87], v4 offset:13312
    ds_read_b128 v[88:91], v4 offset:14336
    ds_read_b128 v[92:95], v4 offset:15360
    s_lshl_b32 s62, s101, 10
    s_add_u32 s42, s30, s62
    s_addc_u32 s43, s31, 0
    s_add_u32 s42, s42, 65536
    s_addc_u32 s43, s43, 0
    s_waitcnt lgkmcnt(0)
    v_add_f32 v64, v64, v80
    v_add_f32 v65, v65, v81
    v_add_f32 v66, v66, v82
    v_add_f32 v67, v67, v83
    v_add_f32 v68, v68, v84
    v_add_f32 v69, v69, v85
    v_add_f32 v70, v70, v86
    v_add_f32 v71, v71, v87
    v_add_f32 v72, v72, v88
    v_add_f32 v73, v73, v89
    v_add_f32 v74, v74, v90
    v_add_f32 v75, v75, v91
    v_add_f32 v76, v76, v92
    v_add_f32 v77, v77, v93
    v_add_f32 v78, v78, v94
    v_add_f32 v79, v79, v95
    v_add_f32 v64, v64, v72
    v_add_f32 v65, v65, v73
    v_add_f32 v66, v66, v74
    v_add_f32 v67, v67, v75
    v_add_f32 v68, v68, v76
    v_add_f32 v69, v69, v77
    v_add_f32 v70, v70, v78
    v_add_f32 v71, v71, v79
    v_add_f32 v64, v64, v68
    v_add_f32 v65, v65, v69
    v_add_f32 v66, v66, v70
    v_add_f32 v67, v67, v71
    v_perm_b32 v64, v64, v3, s34
    v_perm_b32 v65, v65, v3, s35
    v_perm_b32 v66, v66, v3, s36
    v_perm_b32 v67, v67, v3, s37
    s_cmp_lg_u32 s90, 0
    s_cbranch_scc1 L_sl_7
    global_store_dwordx4 v4, v[64:67], s[42:43] sc1
    s_branch L_sd_8
L_sl_7:
    global_store_dwordx4 v4, v[64:67], s[42:43]
L_sd_8:
L_skip_6:
    v_mov_b32 v29, v160
    s_and_b32 s62, s3, 3
    s_lshl_b32 s62, s62, 20
    s_lshl_b32 s63, s2, 8
    s_add_u32 s62, s62, s63
    s_add_u32 s40, s12, s62
    s_addc_u32 s41, s13, 0
    s_lshl_b32 s62, s2, 17
    s_lshr_b32 s63, s3, 2
    s_lshl_b32 s63, s63, 16
    s_add_u32 s62, s62, s63
    s_and_b32 s63, s3, 3
    s_lshl_b32 s63, s63, 8
    s_add_u32 s62, s62, s63
    s_add_u32 s44, s14, s62
    s_addc_u32 s45, s15, 0
    v_lshlrev_b32 v28, 16, v2
    v_lshl_add_u32 v28, v1, 4, v28
    s_and_b32 s62, s3, 3
    s_lshl_b32 s62, s62, 15
    s_lshr_b32 s63, s3, 2
    s_lshl_b32 s63, s63, 14
    s_add_u32 s62, s62, s63
    s_add_u32 s62, s62, 32768
    v_lshlrev_b32 v31, 4, v0
    v_add_u32 v30, s62, v31
    s_lshl_b32 s53, s3, 10
    s_add_u32 s53, s53, 16640
    s_waitcnt vmcnt(2)
    global_load_dwordx4 v[192:195], v29, s[44:45] offset:0 nt
    s_waitcnt vmcnt(2)
    global_load_dwordx4 v[196:199], v29, s[44:45] offset:1024 nt
    s_waitcnt vmcnt(2)
    global_load_dwordx4 v[200:203], v29, s[44:45] offset:2048 nt
    s_waitcnt vmcnt(2)
    global_load_dwordx4 v[204:207], v29, s[44:45] offset:3072 nt
    s_add_u32 s44, s44, 4096
    s_addc_u32 s45, s45, 0
    s_waitcnt vmcnt(2)
    global_load_dwordx4 v[208:211], v29, s[44:45] offset:0 nt
    s_waitcnt vmcnt(2)
    global_load_dwordx4 v[212:215], v29, s[44:45] offset:1024 nt
    s_waitcnt vmcnt(2)
    global_load_dwordx4 v[216:219], v29, s[44:45] offset:2048 nt
    s_waitcnt vmcnt(2)
    global_load_dwordx4 v[220:223], v29, s[44:45] offset:3072 nt
    s_add_u32 s44, s44, 28672
    s_addc_u32 s45, s45, 0
    s_waitcnt vmcnt(2)
    global_load_dwordx4 v[224:227], v29, s[44:45] offset:0 nt
    s_waitcnt vmcnt(2)
    global_load_dwordx4 v[228:231], v29, s[44:45] offset:1024 nt
    s_waitcnt vmcnt(2)
    global_load_dwordx4 v[232:235], v29, s[44:45] offset:2048 nt
    s_waitcnt vmcnt(2)
    global_load_dwordx4 v[236:239], v29, s[44:45] offset:3072 nt
    s_add_u32 s44, s44, 4096
    s_addc_u32 s45, s45, 0
    s_waitcnt vmcnt(4)
    v_perm_b32 v8, v196, v192, s38
    v_perm_b32 v9, v204, v200, s38
    v_perm_b32 v10, v212, v208, s38
    v_perm_b32 v11, v220, v216, s38
    ds_write_b128 v30, v[8:11] offset:0
    v_perm_b32 v12, v196, v192, s39
    v_perm_b32 v13, v204, v200, s39
    v_perm_b32 v14, v212, v208, s39
    v_perm_b32 v15, v220, v216, s39
    ds_write_b128 v30, v[12:15] offset:1024
    v_perm_b32 v16, v197, v193, s38
    v_perm_b32 v17, v205, v201, s38
    v_perm_b32 v18, v213, v209, s38
    v_perm_b32 v19, v221, v217, s38
    ds_write_b128 v30, v[16:19] offset:2048
    v_perm_b32 v20, v197, v193, s39
    v_perm_b32 v21, v205, v201, s39
    v_perm_b32 v22, v213, v209, s39
    v_perm_b32 v23, v221, v217, s39
    ds_write_b128 v30, v[20:23] offset:3072
    v_perm_b32 v8, v198, v194, s38
    v_perm_b32 v9, v206, v202, s38
    v_perm_b32 v10, v214, v210, s38
    v_perm_b32 v11, v222, v218, s38
    ds_write_b128 v30, v[8:11] offset:4096
    v_perm_b32 v12, v198, v194, s39
    v_perm_b32 v13, v206, v202, s39
    v_perm_b32 v14, v214, v210, s39
    v_perm_b32 v15, v222, v218, s39
    ds_write_b128 v30, v[12:15] offset:5120
    v_perm_b32 v16, v199, v195, s38
    v_perm_b32 v17, v207, v203, s38
    v_perm_b32 v18, v215, v211, s38
    v_perm_b32 v19, v223, v219, s38
    ds_write_b128 v30, v[16:19] offset:6144
    v_perm_b32 v20, v199, v195, s39
    v_perm_b32 v21, v207, v203, s39
    v_perm_b32 v22, v215, v211, s39
    v_perm_b32 v23, v223, v219, s39
    ds_write_b128 v30, v[20:23] offset:7168
    s_waitcnt vmcnt(2)
    global_load_dwordx4 v[240:243], v29, s[44:45] offset:0 nt
    s_waitcnt vmcnt(2)
    global_load_dwordx4 v[244:247], v29, s[44:45] offset:1024 nt
    s_waitcnt vmcnt(2)
    global_load_dwordx4 v[248:251], v29, s[44:45] offset:2048 nt
    s_waitcnt vmcnt(2)
    global_load_dwordx4 v[252:255], v29, s[44:45] offset:3072 nt
    s_add_u32 s44, s44, 28672
    s_addc_u32 s45, s45, 0
    s_cmp_ge_u32 s3, 4
    s_cbranch_scc1 L_ldB
    s_waitcnt vmcnt(2)
    global_load_dwordx4 v[64:67], v28, s[40:41] offset:0 nt
    s_add_u32 s40, s40, 8192
    s_addc_u32 s41, s41, 0
    s_waitcnt vmcnt(2)
    global_load_dwordx4 v[68:71], v28, s[40:41] offset:0 nt
    s_add_u32 s40, s40, 8192
    s_addc_u32 s41, s41, 0
    s_waitcnt vmcnt(2)
    global_load_dwordx4 v[72:75], v28, s[40:41] offset:0 nt
    s_add_u32 s40, s40, 8192
    s_addc_u32 s41, s41, 0
    s_waitcnt vmcnt(2)
    global_load_dwordx4 v[76:79], v28, s[40:41] offset:0 nt
    s_add_u32 s40, s40, 8192
    s_addc_u32 s41, s41, 0
    s_waitcnt vmcnt(4)
    v_perm_b32 v8, v228, v224, s38
    v_perm_b32 v9, v236, v232, s38
    v_perm_b32 v10, v244, v240, s38
    v_perm_b32 v11, v252, v248, s38
    ds_write_b128 v30, v[8:11] offset:8192
    v_perm_b32 v12, v228, v224, s39
    v_perm_b32 v13, v236, v232, s39
    v_perm_b32 v14, v244, v240, s39
    v_perm_b32 v15, v252, v248, s39
    ds_write_b128 v30, v[12:15] offset:9216
    v_perm_b32 v16, v229, v225, s38
    v_perm_b32 v17, v237, v233, s38
    v_perm_b32 v18, v245, v241, s38
    v_perm_b32 v19, v253, v249, s38
    ds_write_b128 v30, v[16:19] offset:10240
    v_perm_b32 v20, v229, v225, s39
    v_perm_b32 v21, v237, v233, s39
    v_perm_b32 v22, v245, v241, s39
    v_perm_b32 v23, v253, v249, s39
    ds_write_b128 v30, v[20:23] offset:11264
    v_perm_b32 v8, v230, v226, s38
    v_perm_b32 v9, v238, v234, s38
    v_perm_b32 v10, v246, v242, s38
    v_perm_b32 v11, v254, v250, s38
    ds_write_b128 v30, v[8:11] offset:12288
    v_perm_b32 v12, v230, v226, s39
    v_perm_b32 v13, v238, v234, s39
    v_perm_b32 v14, v246, v242, s39
    v_perm_b32 v15, v254, v250, s39
    ds_write_b128 v30, v[12:15] offset:13312
    v_perm_b32 v16, v231, v227, s38
    v_perm_b32 v17, v239, v235, s38
    v_perm_b32 v18, v247, v243, s38
    v_perm_b32 v19, v255, v251, s38
    ds_write_b128 v30, v[16:19] offset:14336
    v_perm_b32 v20, v231, v227, s39
    v_perm_b32 v21, v239, v235, s39
    v_perm_b32 v22, v247, v243, s39
    v_perm_b32 v23, v255, v251, s39
    ds_write_b128 v30, v[20:23] offset:15360
    v_mov_b32 v6, 1
    v_mov_b32 v7, 16384
    s_mov_b32 exec_lo, 0x1
    s_mov_b32 exec_hi, 0x0
    ds_add_u32 v7, v6
    s_mov_b64 exec, -1
    s_waitcnt vmcnt(2)
    global_load_dwordx4 v[80:83], v28, s[40:41] offset:0 nt
    s_add_u32 s40, s40, 8192
    s_addc_u32 s41, s41, 0
    s_waitcnt vmcnt(2)
    global_load_dwordx4 v[84:87], v28, s[40:41] offset:0 nt
    s_add_u32 s40, s40, 8192
    s_addc_u32 s41, s41, 0
    s_waitcnt vmcnt(2)
    global_load_dwordx4 v[88:91], v28, s[40:41] offset:0 nt
    s_add_u32 s40, s40, 8192
    s_addc_u32 s41, s41, 0
    s_waitcnt vmcnt(2)
    global_load_dwordx4 v[92:95], v28, s[40:41] offset:0 nt
    s_add_u32 s40, s40, 204800
    s_addc_u32 s41, s41, 0
    s_waitcnt vmcnt(2)
    global_load_dwordx4 v[96:99], v28, s[40:41] offset:0 nt
    s_add_u32 s40, s40, 8192
    s_addc_u32 s41, s41, 0
    s_waitcnt vmcnt(2)
    global_load_dwordx4 v[100:103], v28, s[40:41] offset:0 nt
    s_add_u32 s40, s40, 8192
    s_addc_u32 s41, s41, 0
    s_waitcnt vmcnt(2)
    global_load_dwordx4 v[104:107], v28, s[40:41] offset:0 nt
    s_add_u32 s40, s40, 8192
    s_addc_u32 s41, s41, 0
    s_waitcnt vmcnt(2)
    global_load_dwordx4 v[108:111], v28, s[40:41] offset:0 nt
    s_add_u32 s40, s40, 8192
    s_addc_u32 s41, s41, 0
    s_waitcnt vmcnt(4)
    v_perm_b32 v32, v68, v64, s38
    v_perm_b32 v33, v76, v72, s38
    v_perm_b32 v34, v84, v80, s38
    v_perm_b32 v35, v92, v88, s38
    v_perm_b32 v36, v68, v64, s39
    v_perm_b32 v37, v76, v72, s39
    v_perm_b32 v38, v84, v80, s39
    v_perm_b32 v39, v92, v88, s39
    v_perm_b32 v40, v69, v65, s38
    v_perm_b32 v41, v77, v73, s38
    v_perm_b32 v42, v85, v81, s38
    v_perm_b32 v43, v93, v89, s38
    v_perm_b32 v44, v69, v65, s39
    v_perm_b32 v45, v77, v73, s39
    v_perm_b32 v46, v85, v81, s39
    v_perm_b32 v47, v93, v89, s39
    v_perm_b32 v48, v70, v66, s38
    v_perm_b32 v49, v78, v74, s38
    v_perm_b32 v50, v86, v82, s38
    v_perm_b32 v51, v94, v90, s38
    v_perm_b32 v52, v70, v66, s39
    v_perm_b32 v53, v78, v74, s39
    v_perm_b32 v54, v86, v82, s39
    v_perm_b32 v55, v94, v90, s39
    v_perm_b32 v56, v71, v67, s38
    v_perm_b32 v57, v79, v75, s38
    v_perm_b32 v58, v87, v83, s38
    v_perm_b32 v59, v95, v91, s38
    v_perm_b32 v60, v71, v67, s39
    v_perm_b32 v61, v79, v75, s39
    v_perm_b32 v62, v87, v83, s39
    v_perm_b32 v63, v95, v91, s39
    s_waitcnt vmcnt(2)
    global_load_dwordx4 v[112:115], v28, s[40:41] offset:0 nt
    s_add_u32 s40, s40, 8192
    s_addc_u32 s41, s41, 0
    s_waitcnt vmcnt(2)
    global_load_dwordx4 v[116:119], v28, s[40:41] offset:0 nt
    s_add_u32 s40, s40, 8192
    s_addc_u32 s41, s41, 0
    s_waitcnt vmcnt(2)
    global_load_dwordx4 v[120:123], v28, s[40:41] offset:0 nt
    s_add_u32 s40, s40, 8192
    s_addc_u32 s41, s41, 0
    s_waitcnt vmcnt(2)
    global_load_dwordx4 v[124:127], v28, s[40:41] offset:0 nt
    s_add_u32 s40, s40, 204800
    s_addc_u32 s41, s41, 0
    s_waitcnt vmcnt(3)
    global_load_dwordx4 v[128:131], v28, s[40:41] offset:0 nt
    s_add_u32 s40, s40, 8192
    s_addc_u32 s41, s41, 0
    s_waitcnt vmcnt(3)
    global_load_dwordx4 v[132:135], v28, s[40:41] offset:0 nt
    s_add_u32 s40, s40, 8192
    s_addc_u32 s41, s41, 0
    s_waitcnt vmcnt(3)
    global_load_dwordx4 v[136:139], v28, s[40:41] offset:0 nt
    s_add_u32 s40, s40, 8192
    s_addc_u32 s41, s41, 0
    s_waitcnt vmcnt(3)
    global_load_dwordx4 v[140:143], v28, s[40:41] offset:0 nt
    s_add_u32 s40, s40, 8192
    s_addc_u32 s41, s41, 0
    s_waitcnt vmcnt(4)
    v_perm_b32 v64, v100, v96, s38
    v_perm_b32 v65, v108, v104, s38
    v_perm_b32 v66, v116, v112, s38
    v_perm_b32 v67, v124, v120, s38
    v_perm_b32 v68, v100, v96, s39
    v_perm_b32 v69, v108, v104, s39
    v_perm_b32 v70, v116, v112, s39
    v_perm_b32 v71, v124, v120, s39
    v_perm_b32 v72, v101, v97, s38
    v_perm_b32 v73, v109, v105, s38
    v_perm_b32 v74, v117, v113, s38
    v_perm_b32 v75, v125, v121, s38
    v_perm_b32 v76, v101, v97, s39
    v_perm_b32 v77, v109, v105, s39
    v_perm_b32 v78, v117, v113, s39
    v_perm_b32 v79, v125, v121, s39
    v_perm_b32 v80, v102, v98, s38
    v_perm_b32 v81, v110, v106, s38
    v_perm_b32 v82, v118, v114, s38
    v_perm_b32 v83, v126, v122, s38
    v_perm_b32 v84, v102, v98, s39
    v_perm_b32 v85, v110, v106, s39
    v_perm_b32 v86, v118, v114, s39
    v_perm_b32 v87, v126, v122, s39
    v_perm_b32 v88, v103, v99, s38
    v_perm_b32 v89, v111, v107, s38
    v_perm_b32 v90, v119, v115, s38
    v_perm_b32 v91, v127, v123, s38
    v_perm_b32 v92, v103, v99, s39
    v_perm_b32 v93, v111, v107, s39
    v_perm_b32 v94, v119, v115, s39
    v_perm_b32 v95, v127, v123, s39
    s_waitcnt vmcnt(3)
    global_load_dwordx4 v[144:147], v28, s[40:41] offset:0 nt
    s_add_u32 s40, s40, 8192
    s_addc_u32 s41, s41, 0
    s_waitcnt vmcnt(3)
    global_load_dwordx4 v[148:151], v28, s[40:41] offset:0 nt
    s_add_u32 s40, s40, 8192
    s_addc_u32 s41, s41, 0
    s_waitcnt vmcnt(3)
    global_load_dwordx4 v[152:155], v28, s[40:41] offset:0 nt
    s_add_u32 s40, s40, 8192
    s_addc_u32 s41, s41, 0
    s_waitcnt vmcnt(3)
    global_load_dwordx4 v[156:159], v28, s[40:41] offset:0 nt
    s_add_u32 s40, s40, 204800
    s_addc_u32 s41, s41, 0
    s_waitcnt vmcnt(3)
    global_load_dwordx4 v[160:163], v28, s[40:41] offset:0 nt
    s_add_u32 s40, s40, 8192
    s_addc_u32 s41, s41, 0
    s_waitcnt vmcnt(3)
    global_load_dwordx4 v[164:167], v28, s[40:41] offset:0 nt
    s_add_u32 s40, s40, 8192
    s_addc_u32 s41, s41, 0
    s_waitcnt vmcnt(3)
    global_load_dwordx4 v[168:171], v28, s[40:41] offset:0 nt
    s_add_u32 s40, s40, 8192
    s_addc_u32 s41, s41, 0
    s_waitcnt vmcnt(3)
    global_load_dwordx4 v[172:175], v28, s[40:41] offset:0 nt
    s_add_u32 s40, s40, 8192
    s_addc_u32 s41, s41, 0
    s_waitcnt vmcnt(4)
    v_perm_b32 v96, v132, v128, s38
    v_perm_b32 v97, v140, v136, s38
    v_perm_b32 v98, v148, v144, s38
    v_perm_b32 v99, v156, v152, s38
    v_perm_b32 v100, v132, v128, s39
    v_perm_b32 v101, v140, v136, s39
    v_perm_b32 v102, v148, v144, s39
    v_perm_b32 v103, v156, v152, s39
    v_perm_b32 v104, v133, v129, s38
    v_perm_b32 v105, v141, v137, s38
    v_perm_b32 v106, v149, v145, s38
    v_perm_b32 v107, v157, v153, s38
    v_perm_b32 v108, v133, v129, s39
    v_perm_b32 v109, v141, v137, s39
    v_perm_b32 v110, v149, v145, s39
    v_perm_b32 v111, v157, v153, s39
    v_perm_b32 v112, v134, v130, s38
    v_perm_b32 v113, v142, v138, s38
    v_perm_b32 v114, v150, v146, s38
    v_perm_b32 v115, v158, v154, s38
    v_perm_b32 v116, v134, v130, s39
    v_perm_b32 v117, v142, v138, s39
    v_perm_b32 v118, v150, v146, s39
    v_perm_b32 v119, v158, v154, s39
    v_perm_b32 v120, v135, v131, s38
    v_perm_b32 v121, v143, v139, s38
    v_perm_b32 v122, v151, v147, s38
    v_perm_b32 v123, v159, v155, s38
    v_perm_b32 v124, v135, v131, s39
    v_perm_b32 v125, v143, v139, s39
    v_perm_b32 v126, v151, v147, s39
    v_perm_b32 v127, v159, v155, s39
    s_waitcnt vmcnt(3)
    global_load_dwordx4 v[176:179], v28, s[40:41] offset:0 nt
    s_add_u32 s40, s40, 8192
    s_addc_u32 s41, s41, 0
    s_waitcnt vmcnt(3)
    global_load_dwordx4 v[180:183], v28, s[40:41] offset:0 nt
    s_add_u32 s40, s40, 8192
    s_addc_u32 s41, s41, 0
    s_waitcnt vmcnt(3)
    global_load_dwordx4 v[184:187], v28, s[40:41] offset:0 nt
    s_add_u32 s40, s40, 8192
    s_addc_u32 s41, s41, 0
    s_waitcnt vmcnt(3)
    global_load_dwordx4 v[188:191], v28, s[40:41] offset:0 nt
    s_add_u32 s40, s40, 204800
    s_addc_u32 s41, s41, 0
    s_waitcnt vmcnt(0)
    v_perm_b32 v128, v164, v160, s38
    v_perm_b32 v129, v172, v168, s38
    v_perm_b32 v130, v180, v176, s38
    v_perm_b32 v131, v188, v184, s38
    v_perm_b32 v132, v164, v160, s39
    v_perm_b32 v133, v172, v168, s39
    v_perm_b32 v134, v180, v176, s39
    v_perm_b32 v135, v188, v184, s39
    v_perm_b32 v136, v165, v161, s38
    v_perm_b32 v137, v173, v169, s38
    v_perm_b32 v138, v181, v177, s38
    v_perm_b32 v139, v189, v185, s38
    v_perm_b32 v140, v165, v161, s39
    v_perm_b32 v141, v173, v169, s39
    v_perm_b32 v142, v181, v177, s39
    v_perm_b32 v143, v189, v185, s39
    v_perm_b32 v144, v166, v162, s38
    v_perm_b32 v145, v174, v170, s38
    v_perm_b32 v146, v182, v178, s38
    v_perm_b32 v147, v190, v186, s38
    v_perm_b32 v148, v166, v162, s39
    v_perm_b32 v149, v174, v170, s39
    v_perm_b32 v150, v182, v178, s39
    v_perm_b32 v151, v190, v186, s39
    v_perm_b32 v152, v167, v163, s38
    v_perm_b32 v153, v175, v171, s38
    v_perm_b32 v154, v183, v179, s38
    v_perm_b32 v155, v191, v187, s38
    v_perm_b32 v156, v167, v163, s39
    v_perm_b32 v157, v175, v171, s39
    v_perm_b32 v158, v183, v179, s39
    v_perm_b32 v159, v191, v187, s39
    s_branch L_ldok
L_ldB:
    s_and_b32 s53, s2, 1
    s_lshl_b32 s53, s53, 3
    s_lshr_b32 s63, s2, 2
    s_add_u32 s53, s53, s63
    s_lshr_b32 s54, s2, 1
    s_and_b32 s54, s54, 1
    s_add_u32 s54, s54, 14
    s_lshr_b32 s55, s2, 1
    s_and_b32 s55, s55, 1
    s_lshl_b32 s55, s55, 2
    s_and_b32 s63, s3, 3
    s_add_u32 s55, s55, s63
    s_mul_i32 s55, s55, 2
    s_add_u32 s55, s55, 464
    s_lshl_b32 s62, s53, 21
    s_lshl_b32 s63, s55, 12
    s_add_u32 s62, s62, s63
    s_add_u32 s40, s18, s62
    s_addc_u32 s41, s19, 0
    s_add_u32 s46, s20, s62
    s_addc_u32 s47, s21, 0
    v_bfe_u32 v26, v0, 1, 1
    v_lshlrev_b32 v26, 11, v26
    v_bfe_u32 v27, v0, 2, 2
    v_lshl_add_u32 v26, v27, 8, v26
    v_lshl_add_u32 v26, v2, 5, v26
    v_and_b32 v27, 1, v0
    v_lshl_add_u32 v24, v27, 4, v26
    v_lshlrev_b32 v25, 4, v0
    v_lshlrev_b32 v26, 10, v2
    v_lshl_add_u32 v26, v1, 4, v26
    s_and_b32 s62, s53, 7
    s_lshl_b32 s62, s62, 14
    s_and_b32 s63, s3, 3
    s_lshl_b32 s63, s63, 12
    s_add_u32 s62, s62, s63
    s_lshr_b32 s63, s53, 3
    s_lshl_b32 s63, s63, 9
    s_add_u32 s62, s62, s63
    s_add_u32 s42, s30, s62
    s_addc_u32 s43, s31, 0
    s_add_u32 s42, s42, 196608
    s_addc_u32 s43, s43, 0
    s_waitcnt vmcnt(2)
    global_load_dwordx4 v[32:35], v24, s[40:41] offset:0 nt
    s_waitcnt vmcnt(2)
    global_load_dwordx4 v[40:43], v24, s[40:41] offset:128 nt
    s_waitcnt vmcnt(2)
    global_load_dwordx4 v[36:39], v24, s[40:41] offset:1024 nt
    s_waitcnt vmcnt(2)
    global_load_dwordx4 v[44:47], v24, s[40:41] offset:1152 nt
    s_add_u32 s40, s40, 4096
    s_addc_u32 s41, s41, 0
    s_waitcnt vmcnt(4)
    v_perm_b32 v8, v228, v224, s38
    v_perm_b32 v9, v236, v232, s38
    v_perm_b32 v10, v244, v240, s38
    v_perm_b32 v11, v252, v248, s38
    ds_write_b128 v30, v[8:11] offset:8192
    v_perm_b32 v12, v228, v224, s39
    v_perm_b32 v13, v236, v232, s39
    v_perm_b32 v14, v244, v240, s39
    v_perm_b32 v15, v252, v248, s39
    ds_write_b128 v30, v[12:15] offset:9216
    v_perm_b32 v16, v229, v225, s38
    v_perm_b32 v17, v237, v233, s38
    v_perm_b32 v18, v245, v241, s38
    v_perm_b32 v19, v253, v249, s38
    ds_write_b128 v30, v[16:19] offset:10240
    v_perm_b32 v20, v229, v225, s39
    v_perm_b32 v21, v237, v233, s39
    v_perm_b32 v22, v245, v241, s39
    v_perm_b32 v23, v253, v249, s39
    ds_write_b128 v30, v[20:23] offset:11264
    v_perm_b32 v8, v230, v226, s38
    v_perm_b32 v9, v238, v234, s38
    v_perm_b32 v10, v246, v242, s38
    v_perm_b32 v11, v254, v250, s38
    ds_write_b128 v30, v[8:11] offset:12288
    v_perm_b32 v12, v230, v226, s39
    v_perm_b32 v13, v238, v234, s39
    v_perm_b32 v14, v246, v242, s39
    v_perm_b32 v15, v254, v250, s39
    ds_write_b128 v30, v[12:15] offset:13312
    v_perm_b32 v16, v231, v227, s38
    v_perm_b32 v17, v239, v235, s38
    v_perm_b32 v18, v247, v243, s38
    v_perm_b32 v19, v255, v251, s38
    ds_write_b128 v30, v[16:19] offset:14336
    v_perm_b32 v20, v231, v227, s39
    v_perm_b32 v21, v239, v235, s39
    v_perm_b32 v22, v247, v243, s39
    v_perm_b32 v23, v255, v251, s39
    ds_write_b128 v30, v[20:23] offset:15360
    v_mov_b32 v6, 1
    v_mov_b32 v7, 16384
    s_mov_b32 exec_lo, 0x1
    s_mov_b32 exec_hi, 0x0
    ds_add_u32 v7, v6
    s_mov_b64 exec, -1
    s_cmp_ge_u32 s3, 6
    s_cbranch_scc0 L_skip_9
    s_and_b32 s62, s53, 7
    s_lshl_b32 s62, s62, 7
    s_add_u32 s60, s30, s62
    s_addc_u32 s61, s31, 0
    s_add_u32 s60, s60, 638976
    s_addc_u32 s61, s61, 0
    v_and_b32 v16, 31, v0
    v_lshlrev_b32 v16, 2, v16
    global_load_dword v16, v16, s[60:61] sc1
L_skip_9:
    global_load_dwordx4 v[8:11], v26, s[42:43] offset:0 sc1
    global_load_dwordx4 v[12:15], v26, s[42:43] offset:256 sc1
    s_waitcnt vmcnt(2)
    global_load_dwordx4 v[48:51], v24, s[40:41] offset:0 nt
    s_waitcnt vmcnt(2)
    global_load_dwordx4 v[56:59], v24, s[40:41] offset:128 nt
    s_waitcnt vmcnt(2)
    global_load_dwordx4 v[52:55], v24, s[40:41] offset:1024 nt
    s_waitcnt vmcnt(2)
    global_load_dwordx4 v[60:63], v24, s[40:41] offset:1152 nt
    s_add_u32 s40, s40, 4096
    s_addc_u32 s41, s41, 0
    s_waitcnt vmcnt(2)
    global_load_dwordx4 v[96:99], v25, s[46:47] offset:0 nt
    s_waitcnt vmcnt(2)
    global_load_dwordx4 v[100:103], v25, s[46:47] offset:1024 nt
    s_waitcnt vmcnt(2)
    global_load_dwordx4 v[104:107], v25, s[46:47] offset:2048 nt
    s_waitcnt vmcnt(2)
    global_load_dwordx4 v[108:111], v25, s[46:47] offset:3072 nt
    s_add_u32 s46, s46, 4096
    s_addc_u32 s47, s47, 0
    s_mov_b32 s52, 2097152
    s_waitcnt vmcnt(8)
    v_perm_b32 v5, v11, v8, s48
    v_xor_b32 v4, s49, v5
    v_perm_b32 v5, v15, v12, s48
    v_xad_u32 v4, v5, s49, v4
    v_cmp_ne_u32 s[60:61], 0, v4
    s_nop 0
    s_cmp_eq_u64 s[60:61], 0
    s_cbranch_scc1 L_got_11
L_poll_10:
    s_sub_u32 s52, s52, 1
    s_cbranch_scc1 L_got_11
    global_load_dwordx4 v[8:11], v26, s[42:43] offset:0 sc1
    global_load_dwordx4 v[12:15], v26, s[42:43] offset:256 sc1
    s_waitcnt vmcnt(0)
    v_perm_b32 v5, v11, v8, s48
    v_xor_b32 v4, s49, v5
    v_perm_b32 v5, v15, v12, s48
    v_xad_u32 v4, v5, s49, v4
    v_cmp_ne_u32 s[60:61], 0, v4
    s_nop 0
    s_cmp_eq_u64 s[60:61], 0
    s_cbranch_scc0 L_poll_10
L_got_11:
    s_cmp_ge_u32 s3, 6
    s_cbranch_scc0 L_skip_12
    v_cmp_ne_u32 s[60:61], s33, v16
    s_nop 0
    s_cmp_eq_u64 s[60:61], 0
    s_cselect_b32 s90, 1, 0
L_skip_12:
    v_and_b32 v8, s50, v8
    v_and_b32 v9, s50, v9
    v_and_b32 v10, s50, v10
    v_and_b32 v11, s50, v11
    v_and_b32 v12, s50, v12
    v_and_b32 v13, s50, v13
    v_and_b32 v14, s50, v14
    v_and_b32 v15, s50, v15
    v_mov_b32 v224, v8
    v_mov_b32 v225, v9
    v_mov_b32 v226, v10
    v_mov_b32 v227, v11
    v_permlane16_swap_b32 v224, v8
    v_permlane16_swap_b32 v225, v9
    v_permlane16_swap_b32 v226, v10
    v_permlane16_swap_b32 v227, v11
    v_add_f32 v8, v8, v224
    v_add_f32 v9, v9, v225
    v_add_f32 v10, v10, v226
    v_add_f32 v11, v11, v227
    v_mov_b32 v224, v8
    v_mov_b32 v225, v9
    v_mov_b32 v226, v10
    v_mov_b32 v227, v11
    v_permlane32_swap_b32 v224, v8
    v_permlane32_swap_b32 v225, v9
    v_permlane32_swap_b32 v226, v10
    v_permlane32_swap_b32 v227, v11
    v_add_f32 v8, v8, v224
    v_add_f32 v9, v9, v225
    v_add_f32 v10, v10, v226
    v_add_f32 v11, v11, v227
    v_cvt_pk_bf16_f32 v8, v8, v9
    v_cvt_pk_bf16_f32 v9, v10, v11
    v_mov_b32 v224, v12
    v_mov_b32 v225, v13
    v_mov_b32 v226, v14
    v_mov_b32 v227, v15
    v_permlane16_swap_b32 v224, v12
    v_permlane16_swap_b32 v225, v13
    v_permlane16_swap_b32 v226, v14
    v_permlane16_swap_b32 v227, v15
    v_add_f32 v12, v12, v224
    v_add_f32 v13, v13, v225
    v_add_f32 v14, v14, v226
    v_add_f32 v15, v15, v227
    v_mov_b32 v224, v12
    v_mov_b32 v225, v13
    v_mov_b32 v226, v14
    v_mov_b32 v227, v15
    v_permlane32_swap_b32 v224, v12
    v_permlane32_swap_b32 v225, v13
    v_permlane32_swap_b32 v226, v14
    v_permlane32_swap_b32 v227, v15
    v_add_f32 v12, v12, v224
    v_add_f32 v13, v13, v225
    v_add_f32 v14, v14, v226
    v_add_f32 v15, v15, v227
    v_cvt_pk_bf16_f32 v12, v12, v13
    v_cvt_pk_bf16_f32 v13, v14, v15
    s_and_b32 s62, s3, 3
    s_lshl_b32 s62, s62, 8
    v_lshlrev_b32 v4, 3, v1
    v_add_u32 v4, s62, v4
    s_mov_b32 exec_lo, 0xffff
    s_mov_b32 exec_hi, 0x0
    ds_write_b64 v4, v[8:9] offset:26624
    ds_write_b64 v4, v[12:13] offset:26752
    v_mov_b32 v6, 1
    v_mov_b32 v7, 29696
    s_mov_b32 exec_lo, 0x1
    s_mov_b32 exec_hi, 0x0
    ds_add_u32 v7, v6
    s_mov_b64 exec, -1
    s_waitcnt vmcnt(2)
    global_load_dwordx4 v[112:115], v25, s[46:47] offset:0 nt
    s_waitcnt vmcnt(2)
    global_load_dwordx4 v[116:119], v25, s[46:47] offset:1024 nt
    s_waitcnt vmcnt(2)
    global_load_dwordx4 v[120:123], v25, s[46:47] offset:2048 nt
    s_waitcnt vmcnt(2)
    global_load_dwordx4 v[124:127], v25, s[46:47] offset:3072 nt
    s_add_u32 s46, s46, 4096
    s_addc_u32 s47, s47, 0
    v_mov_b32 v7, 29696
    s_mov_b32 s52, 33554432
L_cnt_13:
    ds_read_b32 v6, v7
    s_sub_u32 s52, s52, 1
    s_cbranch_scc1 L_cntok_14
    s_waitcnt lgkmcnt(0)
    v_readfirstlane_b32 s62, v6
    s_nop 0
    s_cmp_lt_u32 s62, 4
    s_cbranch_scc1 L_cnt_13
L_cntok_14:
    v_lshrrev_b32 v4, 2, v1
    v_lshlrev_b32 v4, 8, v4
    v_lshl_add_u32 v4, v2, 5, v4
    ds_read_b128 v[160:163], v4 offset:26624
    ds_read_b128 v[164:167], v4 offset:26640
    ds_read_b128 v[168:171], v4 offset:26752
    ds_read_b128 v[172:175], v4 offset:26768
    s_waitcnt lgkmcnt(0)
    s_waitcnt vmcnt(14)
    s_mov_b64 vcc, s[96:97]
    v_cndmask_b32_dpp v224, v36, v32, vcc quad_perm:[1,0,3,2] row_mask:0xf bank_mask:0xf
    v_xor_b32 v32, v32, v224
    v_cndmask_b32_dpp v225, v37, v33, vcc quad_perm:[1,0,3,2] row_mask:0xf bank_mask:0xf
    v_xor_b32 v33, v33, v225
    v_cndmask_b32_dpp v226, v38, v34, vcc quad_perm:[1,0,3,2] row_mask:0xf bank_mask:0xf
    v_xor_b32 v34, v34, v226
    v_cndmask_b32_dpp v227, v39, v35, vcc quad_perm:[1,0,3,2] row_mask:0xf bank_mask:0xf
    v_xor_b32 v35, v35, v227
    v_xor_b32_dpp v36, v32, v36 quad_perm:[1,0,3,2] row_mask:0xf bank_mask:0xf
    v_xor_b32_dpp v37, v33, v37 quad_perm:[1,0,3,2] row_mask:0xf bank_mask:0xf
    v_xor_b32_dpp v38, v34, v38 quad_perm:[1,0,3,2] row_mask:0xf bank_mask:0xf
    v_xor_b32_dpp v39, v35, v39 quad_perm:[1,0,3,2] row_mask:0xf bank_mask:0xf
    v_cndmask_b32_dpp v228, v44, v40, vcc quad_perm:[1,0,3,2] row_mask:0xf bank_mask:0xf
    v_xor_b32 v40, v40, v228
    v_cndmask_b32_dpp v229, v45, v41, vcc quad_perm:[1,0,3,2] row_mask:0xf bank_mask:0xf
    v_xor_b32 v41, v41, v229
    v_cndmask_b32_dpp v230, v46, v42, vcc quad_perm:[1,0,3,2] row_mask:0xf bank_mask:0xf
    v_xor_b32 v42, v42, v230
    v_cndmask_b32_dpp v231, v47, v43, vcc quad_perm:[1,0,3,2] row_mask:0xf bank_mask:0xf
    v_xor_b32 v43, v43, v231
    v_xor_b32_dpp v44, v40, v44 quad_perm:[1,0,3,2] row_mask:0xf bank_mask:0xf
    v_xor_b32_dpp v45, v41, v45 quad_perm:[1,0,3,2] row_mask:0xf bank_mask:0xf
    v_xor_b32_dpp v46, v42, v46 quad_perm:[1,0,3,2] row_mask:0xf bank_mask:0xf
    v_xor_b32_dpp v47, v43, v47 quad_perm:[1,0,3,2] row_mask:0xf bank_mask:0xf
    v_mfma_f32_16x16x32_bf16 v[176:179], v[224:227], v[160:163], 0
    v_mfma_f32_16x16x32_bf16 v[176:179], v[36:39], v[164:167], v[176:179]
    v_mfma_f32_16x16x32_bf16 v[176:179], v[228:231], v[168:171], v[176:179]
    v_mfma_f32_16x16x32_bf16 v[176:179], v[44:47], v[172:175], v[176:179]
    s_waitcnt vmcnt(8)
    s_mov_b64 vcc, s[96:97]
    v_cndmask_b32_dpp v232, v52, v48, vcc quad_perm:[1,0,3,2] row_mask:0xf bank_mask:0xf
    v_xor_b32 v48, v48, v232
    v_cndmask_b32_dpp v233, v53, v49, vcc quad_perm:[1,0,3,2] row_mask:0xf bank_mask:0xf
    v_xor_b32 v49, v49, v233
    v_cndmask_b32_dpp v234, v54, v50, vcc quad_perm:[1,0,3,2] row_mask:0xf bank_mask:0xf
    v_xor_b32 v50, v50, v234
    v_cndmask_b32_dpp v235, v55, v51, vcc quad_perm:[1,0,3,2] row_mask:0xf bank_mask:0xf
    v_xor_b32 v51, v51, v235
    v_xor_b32_dpp v52, v48, v52 quad_perm:[1,0,3,2] row_mask:0xf bank_mask:0xf
    v_xor_b32_dpp v53, v49, v53 quad_perm:[1,0,3,2] row_mask:0xf bank_mask:0xf
    v_xor_b32_dpp v54, v50, v54 quad_perm:[1,0,3,2] row_mask:0xf bank_mask:0xf
    v_xor_b32_dpp v55, v51, v55 quad_perm:[1,0,3,2] row_mask:0xf bank_mask:0xf
    v_cndmask_b32_dpp v236, v60, v56, vcc quad_perm:[1,0,3,2] row_mask:0xf bank_mask:0xf
    v_xor_b32 v56, v56, v236
    v_cndmask_b32_dpp v237, v61, v57, vcc quad_perm:[1,0,3,2] row_mask:0xf bank_mask:0xf
    v_xor_b32 v57, v57, v237
    v_cndmask_b32_dpp v238, v62, v58, vcc quad_perm:[1,0,3,2] row_mask:0xf bank_mask:0xf
    v_xor_b32 v58, v58, v238
    v_cndmask_b32_dpp v239, v63, v59, vcc quad_perm:[1,0,3,2] row_mask:0xf bank_mask:0xf
    v_xor_b32 v59, v59, v239
    v_xor_b32_dpp v60, v56, v60 quad_perm:[1,0,3,2] row_mask:0xf bank_mask:0xf
    v_xor_b32_dpp v61, v57, v61 quad_perm:[1,0,3,2] row_mask:0xf bank_mask:0xf
    v_xor_b32_dpp v62, v58, v62 quad_perm:[1,0,3,2] row_mask:0xf bank_mask:0xf
    v_xor_b32_dpp v63, v59, v63 quad_perm:[1,0,3,2] row_mask:0xf bank_mask:0xf
    v_mfma_f32_16x16x32_bf16 v[180:183], v[232:235], v[160:163], 0
    v_mfma_f32_16x16x32_bf16 v[180:183], v[52:55], v[164:167], v[180:183]
    v_mfma_f32_16x16x32_bf16 v[180:183], v[236:239], v[168:171], v[180:183]
    v_mfma_f32_16x16x32_bf16 v[180:183], v[60:63], v[172:175], v[180:183]
    v_max3_f32 v4, v176, v177, v178
    s_nop 6
    v_max3_f32 v4, v4, v179, v180
    v_max3_f32 v4, v4, v181, v182
    v_max_f32 v4, v4, v183
    v_mov_b32 v5, v4
    s_nop 1
    v_permlane16_swap_b32 v5, v4
    v_max_f32 v4, v4, v5
    v_mov_b32 v5, v4
    s_nop 1
    v_permlane32_swap_b32 v5, v4
    v_max_f32 v4, v4, v5
    v_mul_f32 v4, s51, v4
    v_fma_f32 v176, v176, s51, -v4
    v_fma_f32 v177, v177, s51, -v4
    v_fma_f32 v178, v178, s51, -v4
    v_fma_f32 v179, v179, s51, -v4
    v_fma_f32 v180, v180, s51, -v4
    v_fma_f32 v181, v181, s51, -v4
    v_fma_f32 v182, v182, s51, -v4
    v_fma_f32 v183, v183, s51, -v4
    v_exp_f32 v176, v176
    v_exp_f32 v177, v177
    v_exp_f32 v178, v178
    v_exp_f32 v179, v179
    v_exp_f32 v180, v180
    v_exp_f32 v181, v181
    v_exp_f32 v182, v182
    v_exp_f32 v183, v183
    v_add_f32 v5, v176, v177
    v_add_f32 v5, v5, v178
    v_add_f32 v5, v5, v179
    v_add_f32 v5, v5, v180
    v_add_f32 v5, v5, v181
    v_add_f32 v5, v5, v182
    v_add_f32 v5, v5, v183
    v_cvt_pk_bf16_f32 v176, v176, v177
    v_cvt_pk_bf16_f32 v177, v178, v179
    v_cvt_pk_bf16_f32 v178, v180, v181
    v_cvt_pk_bf16_f32 v179, v182, v183
    v_mov_b32 v6, v5
    s_nop 1
    v_permlane16_swap_b32 v6, v5
    v_add_f32 v5, v5, v6
    v_mov_b32 v6, v5
    s_nop 1
    v_permlane32_swap_b32 v6, v5
    v_add_f32 v5, v5, v6
    s_lshl_b32 s62, s3, 5
    v_lshlrev_b32 v6, 1, v1
    v_add_u32 v6, s62, v6
    s_mov_b32 exec_lo, 0x1111
    s_mov_b32 exec_hi, 0x0
    ds_write_b64 v6, v[4:5] offset:27648
    v_mov_b32 v6, 1
    v_mov_b32 v7, 29700
    s_mov_b32 exec_lo, 0x1
    s_mov_b32 exec_hi, 0x0
    ds_add_u32 v7, v6
    s_mov_b64 exec, -1
    s_waitcnt vmcnt(0)
    v_perm_b32 v224, v100, v96, s38
    v_perm_b32 v225, v108, v104, s38
    v_perm_b32 v226, v116, v112, s38
    v_perm_b32 v227, v124, v120, s38
    s_nop 1
    v_mfma_f32_16x16x32_bf16 v[192:195], v[176:179], v[224:227], 0
    v_perm_b32 v228, v100, v96, s39
    v_perm_b32 v229, v108, v104, s39
    v_perm_b32 v230, v116, v112, s39
    v_perm_b32 v231, v124, v120, s39
    s_nop 1
    v_mfma_f32_16x16x32_bf16 v[196:199], v[176:179], v[228:231], 0
    v_perm_b32 v232, v101, v97, s38
    v_perm_b32 v233, v109, v105, s38
    v_perm_b32 v234, v117, v113, s38
    v_perm_b32 v235, v125, v121, s38
    s_nop 1
    v_mfma_f32_16x16x32_bf16 v[200:203], v[176:179], v[232:235], 0
    v_perm_b32 v236, v101, v97, s39
    v_perm_b32 v237, v109, v105, s39
    v_perm_b32 v238, v117, v113, s39
    v_perm_b32 v239, v125, v121, s39
    s_nop 1
    v_mfma_f32_16x16x32_bf16 v[204:207], v[176:179], v[236:239], 0
    v_perm_b32 v224, v102, v98, s38
    v_perm_b32 v225, v110, v106, s38
    v_perm_b32 v226, v118, v114, s38
    v_perm_b32 v227, v126, v122, s38
    s_nop 1
    v_mfma_f32_16x16x32_bf16 v[208:211], v[176:179], v[224:227], 0
    v_perm_b32 v228, v102, v98, s39
    v_perm_b32 v229, v110, v106, s39
    v_perm_b32 v230, v118, v114, s39
    v_perm_b32 v231, v126, v122, s39
    s_nop 1
    v_mfma_f32_16x16x32_bf16 v[212:215], v[176:179], v[228:231], 0
    v_perm_b32 v232, v103, v99, s38
    v_perm_b32 v233, v111, v107, s38
    v_perm_b32 v234, v119, v115, s38
    v_perm_b32 v235, v127, v123, s38
    s_nop 1
    v_mfma_f32_16x16x32_bf16 v[216:219], v[176:179], v[232:235], 0
    v_perm_b32 v236, v103, v99, s39
    v_perm_b32 v237, v111, v107, s39
    v_perm_b32 v238, v119, v115, s39
    v_perm_b32 v239, v127, v123, s39
    s_nop 1
    v_mfma_f32_16x16x32_bf16 v[220:223], v[176:179], v[236:239], 0
    v_mov_b32 v7, 29700
    s_mov_b32 s52, 33554432
L_cnt_15:
    ds_read_b32 v6, v7
    s_sub_u32 s52, s52, 1
    s_cbranch_scc1 L_cntok_16
    s_waitcnt lgkmcnt(0)
    v_readfirstlane_b32 s62, v6
    s_nop 0
    s_cmp_lt_u32 s62, 4
    s_cbranch_scc1 L_cnt_15
L_cntok_16:
    v_lshlrev_b32 v6, 3, v2
    ds_read_b64 v[32:33], v6 offset:27776
    ds_read_b64 v[34:35], v6 offset:27808
    ds_read_b64 v[36:37], v6 offset:27840
    ds_read_b64 v[38:39], v6 offset:27872
    s_lshl_b32 s62, s3, 5
    v_add_u32 v6, s62, v6
    ds_read_b64 v[4:5], v6 offset:27648
    s_waitcnt lgkmcnt(0)
    v_max3_f32 v7, v32, v34, v36
    v_max_f32 v7, v7, v38
    v_sub_f32 v32, v32, v7
    v_sub_f32 v34, v34, v7
    v_sub_f32 v36, v36, v7
    v_sub_f32 v38, v38, v7
    v_sub_f32 v4, v4, v7
    v_exp_f32 v32, v32
    v_exp_f32 v34, v34
    v_exp_f32 v36, v36
    v_exp_f32 v38, v38
    v_exp_f32 v4, v4
    v_mul_f32 v5, v32, v33
    v_fmac_f32 v5, v34, v35
    v_fmac_f32 v5, v36, v37
    v_fmac_f32 v5, v38, v39
    v_rcp_f32 v6, v5
    v_log_f32 v5, v5
    v_mul_f32 v27, v4, v6
    s_cmp_eq_u32 s3, 7
    s_cbranch_scc0 L_skip_17
    v_add_f32 v8, v5, v7
    v_add_f32 v9, v5, v7
    v_add_f32 v10, v5, v7
    v_add_f32 v11, v5, v7
    v_perm_b32 v8, v8, v3, s34
    v_perm_b32 v9, v9, v3, s35
    v_perm_b32 v10, v10, v3, s36
    v_perm_b32 v11, v11, v3, s37
    s_and_b32 s62, s53, 7
    s_lshl_b32 s62, s62, 11
    s_lshr_b32 s63, s53, 3
    s_lshl_b32 s63, s63, 8
    s_add_u32 s62, s62, s63
    s_lshl_b32 s63, s54, 4
    s_add_u32 s62, s62, s63
    s_add_u32 s42, s30, s62
    s_addc_u32 s43, s31, 0
    s_add_u32 s42, s42, 655360
    s_addc_u32 s43, s43, 0
    v_lshlrev_b32 v4, 9, v2
    s_mov_b32 exec_lo, 0x10001
    s_mov_b32 exec_hi, 0x10001
    s_cmp_lg_u32 s90, 0
    s_cbranch_scc1 L_sl_18
    global_store_dwordx4 v4, v[8:11], s[42:43] sc1
    s_branch L_sd_19
L_sl_18:
    global_store_dwordx4 v4, v[8:11], s[42:43]
L_sd_19:
    s_mov_b64 exec, -1
L_skip_17:
    s_and_b32 s62, s53, 7
    s_lshl_b32 s62, s62, 3
    s_and_b32 s63, s3, 1
    s_lshl_b32 s63, s63, 2
    s_add_u32 s62, s62, s63
    s_lshr_b32 s63, s53, 3
    s_add_u32 s62, s62, s63
    s_mul_i32 s62, s62, 16
    s_add_u32 s62, s62, s54
    s_lshl_b32 s62, s62, 9
    s_add_u32 s42, s30, s62
    s_addc_u32 s43, s31, 0
    s_add_u32 s42, s42, 720896
    s_addc_u32 s43, s43, 0
    v_lshrrev_b32 v4, 5, v0
    v_mul_u32_u24 v4, 16384, v4
    v_and_b32 v5, 31, v0
    v_lshl_add_u32 v26, v5, 4, v4
    s_lshl_b32 s62, s3, 11
    v_lshlrev_b32 v4, 9, v2
    v_lshl_add_u32 v4, v1, 5, v4
    v_add_u32 v24, s62, v4
    s_and_b32 s62, s3, 1
    s_lshl_b32 s62, s62, 10
    v_add_u32 v32, s62, v25
    v_mul_f32 v36, v27, v192
    v_mul_f32 v37, v27, v196
    v_mul_f32 v38, v27, v200
    v_mul_f32 v39, v27, v204
    v_mul_f32 v40, v27, v208
    v_mul_f32 v41, v27, v212
    v_mul_f32 v42, v27, v216
    v_mul_f32 v43, v27, v220
    ds_write_b128 v24, v[36:39] offset:0
    ds_write_b128 v24, v[40:43] offset:16
    v_mov_b32 v6, 1
    v_mov_b32 v7, 29704
    s_mov_b32 exec_lo, 0x1
    s_mov_b32 exec_hi, 0x0
    ds_add_u32 v7, v6
    s_mov_b64 exec, -1
    s_cmp_ge_u32 s3, 6
    s_cbranch_scc0 L_skip_20
    v_mov_b32 v7, 29704
    s_mov_b32 s52, 33554432
L_cnt_21:
    ds_read_b32 v6, v7
    s_sub_u32 s52, s52, 1
    s_cbranch_scc1 L_cntok_22
    s_waitcnt lgkmcnt(0)
    v_readfirstlane_b32 s62, v6
    s_nop 0
    s_cmp_lt_u32 s62, 4
    s_cbranch_scc1 L_cnt_21
L_cntok_22:
    ds_read_b128 v[36:39], v32 offset:8192
    ds_read_b128 v[40:43], v32 offset:10240
    ds_read_b128 v[44:47], v32 offset:12288
    ds_read_b128 v[48:51], v32 offset:14336
    s_waitcnt lgkmcnt(0)
    v_add_f32 v36, v36, v44
    v_add_f32 v37, v37, v45
    v_add_f32 v38, v38, v46
    v_add_f32 v39, v39, v47
    v_add_f32 v40, v40, v48
    v_add_f32 v41, v41, v49
    v_add_f32 v42, v42, v50
    v_add_f32 v43, v43, v51
    v_add_f32 v36, v36, v40
    v_add_f32 v37, v37, v41
    v_add_f32 v38, v38, v42
    v_add_f32 v39, v39, v43
    v_perm_b32 v36, v36, v3, s34
    v_perm_b32 v37, v37, v3, s35
    v_perm_b32 v38, v38, v3, s36
    v_perm_b32 v39, v39, v3, s37
    s_cmp_lg_u32 s90, 0
    s_cbranch_scc1 L_sl_23
    global_store_dwordx4 v26, v[36:39], s[42:43] sc1
    s_branch L_sd_24
L_sl_23:
    global_store_dwordx4 v26, v[36:39], s[42:43]
L_sd_24:
L_skip_20:
    s_branch L_fin
L_ldok:
    v_bfe_u32 v26, v1, 2, 1
    v_lshlrev_b32 v25, 8, v26
    v_lshl_add_u32 v25, v2, 4, v25
    v_lshlrev_b32 v24, 3, v0
    s_lshr_b32 s54, s3, 2
    s_lshl_b32 s62, s54, 17
    s_and_b32 s63, s3, 3
    s_lshl_b32 s63, s63, 15
    s_add_u32 s62, s62, s63
    s_lshl_b32 s63, s2, 7
    s_add_u32 s62, s62, s63
    s_add_u32 s44, s30, s62
    s_addc_u32 s45, s31, 0
    s_add_u32 s44, s44, 1310720
    s_addc_u32 s45, s45, 0
    v_lshrrev_b32 v4, 1, v1
    v_lshlrev_b32 v4, 12, v4
    v_and_b32 v5, 1, v1
    v_lshl_add_u32 v4, v5, 5, v4
    v_and_b32 v5, 1, v2
    v_lshl_add_u32 v4, v5, 6, v4
    v_lshrrev_b32 v5, 1, v2
    v_lshl_add_u32 v23, v5, 4, v4
    s_mov_b32 s46, 0
    s_mov_b32 s47, -1
    s_lshl_b32 s62, s54, 17
    s_lshl_b32 s63, s2, 12
    s_add_u32 s62, s62, s63
    s_add_u32 s86, s30, s62
    s_addc_u32 s87, s31, 0
    s_add_u32 s86, s86, 1310720
    s_addc_u32 s87, s87, 0
    s_lshl_b32 s62, s54, 10
    s_lshl_b32 s63, s2, 5
    s_add_u32 s62, s62, s63
    s_add_u32 s88, s26, s62
    s_addc_u32 s89, s27, 0
    v_bfe_u32 v4, v0, 2, 1
    v_lshlrev_b32 v4, 11, v4
    v_and_b32 v5, 3, v0
    v_lshl_add_u32 v27, v5, 3, v4
    v_bfe_u32 v4, v0, 4, 1
    v_lshl_add_u32 v27, v4, 2, v27
    v_lshrrev_b32 v4, 5, v0
    v_lshl_add_u32 v27, v4, 1, v27
    s_cmp_ge_u32 s3, 4
    s_cbranch_scc1 L_tailB
    s_lshl_b32 s62, s2, 3
    s_add_u32 s40, s30, s62
    s_addc_u32 s41, s31, 0
    s_add_u32 s40, s40, 589824
    s_addc_u32 s41, s41, 0
    v_lshlrev_b32 v22, 8, v0
    s_lshl_b32 s62, s2, 16
    s_lshl_b32 s63, s3, 8
    s_add_u32 s62, s62, s63
    s_add_u32 s98, s30, s62
    s_addc_u32 s99, s31, 0
    s_add_u32 s98, s98, 2097152
    s_addc_u32 s99, s99, 0
    s_add_u32 s100, s98, 4096
    s_addc_u32 s101, s99, 0
    s_add_u32 s56, s98, 32768
    s_addc_u32 s57, s99, 0
    s_add_u32 s42, s98, 36864
    s_addc_u32 s43, s99, 0
    s_mov_b64 s[92:93], 0
    v_lshlrev_b32 v21, 3, v2
    s_mov_b32 s52, 2097152
    v_mov_b32 v7, 16384
    s_mov_b32 s52, 33554432
L_cnt_27:
    ds_read_b32 v6, v7
    s_sub_u32 s52, s52, 1
    s_cbranch_scc1 L_cntok_28
    s_waitcnt lgkmcnt(0)
    v_readfirstlane_b32 s62, v6
    s_nop 0
    s_cmp_lt_u32 s62, 8
    s_cbranch_scc1 L_cnt_27
L_cntok_28:
    s_mov_b32 s52, 2097152
    global_load_dwordx2 v[8:9], v22, s[40:41] sc1
    s_mov_b32 s91, 0
L_lat_25:
    s_sub_u32 s52, s52, 1
    s_cbranch_scc1 L_latok_26
    s_waitcnt vmcnt(8)
    s_cmp_ge_u32 s91, 8
    s_cbranch_scc1 L_lw_29
    s_waitcnt vmcnt(4)
    s_cmp_ge_u32 s91, 4
    s_cbranch_scc1 L_lw_29
    s_waitcnt vmcnt(2)
    s_cmp_ge_u32 s91, 2
    s_cbranch_scc1 L_lw_29
    s_waitcnt vmcnt(1)
    s_cmp_ge_u32 s91, 1
    s_cbranch_scc1 L_lw_29
    s_waitcnt vmcnt(0)
L_lw_29:
    v_cmp_ne_u32 s[60:61], v9, v3
    v_mov_b32 v12, v8
    s_mov_b32 s91, 0
    global_load_dwordx2 v[8:9], v22, s[40:41] sc1
    s_nor_b64 s[94:95], s[60:61], s[92:93]
    s_cbranch_scc0 L_lat_25
    s_or_b64 s[92:93], s[92:93], s[94:95]
    s_cmp_eq_u32 s94, 0
    s_cbranch_scc1 L_lskb_30
    v_lshrrev_b32 v10, v21, s94
    v_and_b32 v11, 1, v10
    v_cmp_ne_u32 vcc, 0, v11
    s_nop 0
    s_and_saveexec_b64 s[62:63], vcc
    s_cbranch_execz L_lsk_31
    global_load_dwordx4 v[192:195], v29, s[98:99] offset:0 sc1 nt
    s_add_u32 s91, s91, 1
L_lsk_31:
    s_mov_b64 exec, -1
    v_and_b32 v11, 2, v10
    v_cmp_ne_u32 vcc, 0, v11
    s_nop 0
    s_and_saveexec_b64 s[62:63], vcc
    s_cbranch_execz L_lsk_32
    global_load_dwordx4 v[196:199], v29, s[98:99] offset:1024 sc1 nt
    s_add_u32 s91, s91, 1
L_lsk_32:
    s_mov_b64 exec, -1
    v_and_b32 v11, 4, v10
    v_cmp_ne_u32 vcc, 0, v11
    s_nop 0
    s_and_saveexec_b64 s[62:63], vcc
    s_cbranch_execz L_lsk_33
    global_load_dwordx4 v[200:203], v29, s[98:99] offset:2048 sc1 nt
    s_add_u32 s91, s91, 1
L_lsk_33:
    s_mov_b64 exec, -1
    v_and_b32 v11, 8, v10
    v_cmp_ne_u32 vcc, 0, v11
    s_nop 0
    s_and_saveexec_b64 s[62:63], vcc
    s_cbranch_execz L_lsk_34
    global_load_dwordx4 v[204:207], v29, s[98:99] offset:3072 sc1 nt
    s_add_u32 s91, s91, 1
L_lsk_34:
    s_mov_b64 exec, -1
    v_and_b32 v11, 16, v10
    v_cmp_ne_u32 vcc, 0, v11
    s_nop 0
    s_and_saveexec_b64 s[62:63], vcc
    s_cbranch_execz L_lsk_35
    global_load_dwordx4 v[208:211], v29, s[100:101] offset:0 sc1 nt
    s_add_u32 s91, s91, 1
L_lsk_35:
    s_mov_b64 exec, -1
    v_and_b32 v11, 32, v10
    v_cmp_ne_u32 vcc, 0, v11
    s_nop 0
    s_and_saveexec_b64 s[62:63], vcc
    s_cbranch_execz L_lsk_36
    global_load_dwordx4 v[212:215], v29, s[100:101] offset:1024 sc1 nt
    s_add_u32 s91, s91, 1
L_lsk_36:
    s_mov_b64 exec, -1
    v_and_b32 v11, 64, v10
    v_cmp_ne_u32 vcc, 0, v11
    s_nop 0
    s_and_saveexec_b64 s[62:63], vcc
    s_cbranch_execz L_lsk_37
    global_load_dwordx4 v[216:219], v29, s[100:101] offset:2048 sc1 nt
    s_add_u32 s91, s91, 1
L_lsk_37:
    s_mov_b64 exec, -1
    v_and_b32 v11, 128, v10
    v_cmp_ne_u32 vcc, 0, v11
    s_nop 0
    s_and_saveexec_b64 s[62:63], vcc
    s_cbranch_execz L_lsk_38
    global_load_dwordx4 v[220:223], v29, s[100:101] offset:3072 sc1 nt
    s_add_u32 s91, s91, 1
L_lsk_38:
    s_mov_b64 exec, -1
L_lskb_30:
    s_cmp_eq_u32 s95, 0
    s_cbranch_scc1 L_lskb_39
    v_lshrrev_b32 v10, v21, s95
    v_and_b32 v11, 1, v10
    v_cmp_ne_u32 vcc, 0, v11
    s_nop 0
    s_and_saveexec_b64 s[62:63], vcc
    s_cbranch_execz L_lsk_40
    global_load_dwordx4 v[224:227], v29, s[56:57] offset:0 sc1 nt
    s_add_u32 s91, s91, 1
L_lsk_40:
    s_mov_b64 exec, -1
    v_and_b32 v11, 2, v10
    v_cmp_ne_u32 vcc, 0, v11
    s_nop 0
    s_and_saveexec_b64 s[62:63], vcc
    s_cbranch_execz L_lsk_41
    global_load_dwordx4 v[228:231], v29, s[56:57] offset:1024 sc1 nt
    s_add_u32 s91, s91, 1
L_lsk_41:
    s_mov_b64 exec, -1
    v_and_b32 v11, 4, v10
    v_cmp_ne_u32 vcc, 0, v11
    s_nop 0
    s_and_saveexec_b64 s[62:63], vcc
    s_cbranch_execz L_lsk_42
    global_load_dwordx4 v[232:235], v29, s[56:57] offset:2048 sc1 nt
    s_add_u32 s91, s91, 1
L_lsk_42:
    s_mov_b64 exec, -1
    v_and_b32 v11, 8, v10
    v_cmp_ne_u32 vcc, 0, v11
    s_nop 0
    s_and_saveexec_b64 s[62:63], vcc
    s_cbranch_execz L_lsk_43
    global_load_dwordx4 v[236:239], v29, s[56:57] offset:3072 sc1 nt
    s_add_u32 s91, s91, 1
L_lsk_43:
    s_mov_b64 exec, -1
    v_and_b32 v11, 16, v10
    v_cmp_ne_u32 vcc, 0, v11
    s_nop 0
    s_and_saveexec_b64 s[62:63], vcc
    s_cbranch_execz L_lsk_44
    global_load_dwordx4 v[240:243], v29, s[42:43] offset:0 sc1 nt
    s_add_u32 s91, s91, 1
L_lsk_44:
    s_mov_b64 exec, -1
    v_and_b32 v11, 32, v10
    v_cmp_ne_u32 vcc, 0, v11
    s_nop 0
    s_and_saveexec_b64 s[62:63], vcc
    s_cbranch_execz L_lsk_45
    global_load_dwordx4 v[244:247], v29, s[42:43] offset:1024 sc1 nt
    s_add_u32 s91, s91, 1
L_lsk_45:
    s_mov_b64 exec, -1
    v_and_b32 v11, 64, v10
    v_cmp_ne_u32 vcc, 0, v11
    s_nop 0
    s_and_saveexec_b64 s[62:63], vcc
    s_cbranch_execz L_lsk_46
    global_load_dwordx4 v[248:251], v29, s[42:43] offset:2048 sc1 nt
    s_add_u32 s91, s91, 1
L_lsk_46:
    s_mov_b64 exec, -1
    v_and_b32 v11, 128, v10
    v_cmp_ne_u32 vcc, 0, v11
    s_nop 0
    s_and_saveexec_b64 s[62:63], vcc
    s_cbranch_execz L_lsk_47
    global_load_dwordx4 v[252:255], v29, s[42:43] offset:3072 sc1 nt
    s_add_u32 s91, s91, 1
L_lsk_47:
    s_mov_b64 exec, -1
L_lskb_39:
    s_cmp_lg_u64 s[92:93], -1
    s_cbranch_scc1 L_lat_25
L_latok_26:
    s_or_b32 s62, s2, s3
    s_cmp_eq_u32 s62, 0
    s_cbranch_scc0 L_skip_48
    v_lshlrev_b32 v4, 2, v0
    s_mov_b32 exec_lo, 0xffffffff
    s_mov_b32 exec_hi, 0x0
    global_store_dword v4, v3, s[30:31]
    s_mov_b64 exec, -1
L_skip_48:
    v_mov_b32 v10, v12
    s_nop 1
    v_max_f32_dpp v10, v10, v10 row_ror:8 row_mask:0xf bank_mask:0xf
    s_nop 1
    v_max_f32_dpp v10, v10, v10 row_ror:4 row_mask:0xf bank_mask:0xf
    s_nop 1
    v_max_f32_dpp v10, v10, v10 row_ror:2 row_mask:0xf bank_mask:0xf
    s_nop 1
    v_max_f32_dpp v10, v10, v10 row_ror:1 row_mask:0xf bank_mask:0xf
    v_mov_b32 v11, v10
    s_nop 1
    v_permlane16_swap_b32 v11, v10
    v_max_f32 v10, v10, v11
    v_sub_f32 v12, v12, v10
    v_exp_f32 v12, v12
    v_lshrrev_b32 v4, 5, v0
    v_mov_b32 v10, v12
    s_nop 1
    v_add_f32_dpp v10, v10, v10 row_ror:8 row_mask:0xf bank_mask:0xf
    s_nop 1
    v_add_f32_dpp v10, v10, v10 row_ror:4 row_mask:0xf bank_mask:0xf
    s_nop 1
    v_add_f32_dpp v10, v10, v10 row_ror:2 row_mask:0xf bank_mask:0xf
    s_nop 1
    v_add_f32_dpp v10, v10, v10 row_ror:1 row_mask:0xf bank_mask:0xf
    v_mov_b32 v11, v10
    s_nop 1
    v_permlane16_swap_b32 v11, v10
    v_add_f32 v10, v10, v11
    v_rcp_f32 v10, v10
    v_lshlrev_b32 v4, 7, v4
    v_mul_f32 v12, v12, v10
    v_cvt_pk_bf16_f32 v13, v12, v12
    v_and_b32 v10, 0xffff0000, v13
    v_sub_f32 v12, v12, v10
    v_cvt_pk_bf16_f32 v10, v12, v12
    v_and_b32 v5, 31, v0
    v_lshl_add_u32 v4, v5, 1, v4
    v_add_u32 v4, s53, v4
    ds_write_b16 v4, v13
    ds_write_b16 v4, v10 offset:64
    v_and_b32 v4, 1, v1
    v_lshlrev_b32 v4, 6, v4
    v_lshl_add_u32 v4, v2, 4, v4
    v_add_u32 v4, s53, v4
    s_waitcnt lgkmcnt(0)
    ds_read_b128 v[184:187], v4
    ds_read_b128 v[12:15], v4 offset:128
    v_lshlrev_b32 v4, 4, v1
    v_add_u32 v4, s53, v4
    v_add_u32 v5, s53, v25
    s_waitcnt lgkmcnt(0)
    s_waitcnt vmcnt(0)
    v_mov_b32 v8, v184
    v_mov_b32 v9, v185
    v_mov_b32 v10, v186
    v_mov_b32 v11, v187
    v_perm_b32 v16, v196, v192, s38
    v_perm_b32 v17, v204, v200, s38
    v_perm_b32 v18, v212, v208, s38
    v_perm_b32 v19, v220, v216, s38
    s_nop 1
    v_mfma_f32_16x16x32_bf16 v[160:163], v[8:11], v[16:19], 0
    v_perm_b32 v16, v196, v192, s39
    v_perm_b32 v17, v204, v200, s39
    v_perm_b32 v18, v212, v208, s39
    v_perm_b32 v19, v220, v216, s39
    s_nop 1
    v_mfma_f32_16x16x32_bf16 v[164:167], v[8:11], v[16:19], 0
    v_perm_b32 v16, v197, v193, s38
    v_perm_b32 v17, v205, v201, s38
    v_perm_b32 v18, v213, v209, s38
    v_perm_b32 v19, v221, v217, s38
    s_nop 1
    v_mfma_f32_16x16x32_bf16 v[168:171], v[8:11], v[16:19], 0
    v_perm_b32 v16, v197, v193, s39
    v_perm_b32 v17, v205, v201, s39
    v_perm_b32 v18, v213, v209, s39
    v_perm_b32 v19, v221, v217, s39
    s_nop 1
    v_mfma_f32_16x16x32_bf16 v[172:175], v[8:11], v[16:19], 0
    v_perm_b32 v16, v198, v194, s38
    v_perm_b32 v17, v206, v202, s38
    v_perm_b32 v18, v214, v210, s38
    v_perm_b32 v19, v222, v218, s38
    s_nop 1
    v_mfma_f32_16x16x32_bf16 v[176:179], v[8:11], v[16:19], 0
    v_perm_b32 v16, v198, v194, s39
    v_perm_b32 v17, v206, v202, s39
    v_perm_b32 v18, v214, v210, s39
    v_perm_b32 v19, v222, v218, s39
    s_nop 1
    v_mfma_f32_16x16x32_bf16 v[180:183], v[8:11], v[16:19], 0
    v_perm_b32 v16, v199, v195, s38
    v_perm_b32 v17, v207, v203, s38
    v_perm_b32 v18, v215, v211, s38
    v_perm_b32 v19, v223, v219, s38
    s_nop 1
    v_mfma_f32_16x16x32_bf16 v[184:187], v[8:11], v[16:19], 0
    v_perm_b32 v16, v199, v195, s39
    v_perm_b32 v17, v207, v203, s39
    v_perm_b32 v18, v215, v211, s39
    v_perm_b32 v19, v223, v219, s39
    s_nop 1
    v_mfma_f32_16x16x32_bf16 v[188:191], v[8:11], v[16:19], 0
    v_add_f32 v160, v160, v161
    v_add_f32 v164, v164, v165
    v_add_f32 v168, v168, v169
    v_add_f32 v172, v172, v173
    v_add_f32 v176, v176, v177
    v_add_f32 v180, v180, v181
    v_add_f32 v184, v184, v185
    s_nop 0
    v_add_f32 v188, v188, v189
    v_cvt_pk_bf16_f32 v192, v160, v164
    v_cvt_pk_bf16_f32 v193, v168, v172
    v_cvt_pk_bf16_f32 v194, v176, v180
    v_cvt_pk_bf16_f32 v195, v184, v188
    s_mov_b32 exec_lo, 0xffff
    s_mov_b32 exec_hi, 0x0
    ds_write_b128 v4, v[192:195] offset:256
    s_mov_b64 exec, -1
    v_perm_b32 v16, v228, v224, s38
    v_perm_b32 v17, v236, v232, s38
    v_perm_b32 v18, v244, v240, s38
    v_perm_b32 v19, v252, v248, s38
    s_nop 1
    v_mfma_f32_16x16x32_bf16 v[160:163], v[12:15], v[16:19], 0
    v_perm_b32 v16, v228, v224, s39
    v_perm_b32 v17, v236, v232, s39
    v_perm_b32 v18, v244, v240, s39
    v_perm_b32 v19, v252, v248, s39
    s_nop 1
    v_mfma_f32_16x16x32_bf16 v[164:167], v[12:15], v[16:19], 0
    v_perm_b32 v16, v229, v225, s38
    v_perm_b32 v17, v237, v233, s38
    v_perm_b32 v18, v245, v241, s38
    v_perm_b32 v19, v253, v249, s38
    s_nop 1
    v_mfma_f32_16x16x32_bf16 v[168:171], v[12:15], v[16:19], 0
    v_perm_b32 v16, v229, v225, s39
    v_perm_b32 v17, v237, v233, s39
    v_perm_b32 v18, v245, v241, s39
    v_perm_b32 v19, v253, v249, s39
    s_nop 1
    v_mfma_f32_16x16x32_bf16 v[172:175], v[12:15], v[16:19], 0
    v_perm_b32 v16, v230, v226, s38
    v_perm_b32 v17, v238, v234, s38
    v_perm_b32 v18, v246, v242, s38
    v_perm_b32 v19, v254, v250, s38
    s_nop 1
    v_mfma_f32_16x16x32_bf16 v[176:179], v[12:15], v[16:19], 0
    v_perm_b32 v16, v230, v226, s39
    v_perm_b32 v17, v238, v234, s39
    v_perm_b32 v18, v246, v242, s39
    v_perm_b32 v19, v254, v250, s39
    s_nop 1
    v_mfma_f32_16x16x32_bf16 v[180:183], v[12:15], v[16:19], 0
    v_perm_b32 v16, v231, v227, s38
    v_perm_b32 v17, v239, v235, s38
    v_perm_b32 v18, v247, v243, s38
    v_perm_b32 v19, v255, v251, s38
    s_nop 1
    v_mfma_f32_16x16x32_bf16 v[184:187], v[12:15], v[16:19], 0
    v_perm_b32 v16, v231, v227, s39
    v_perm_b32 v17, v239, v235, s39
    v_perm_b32 v18, v247, v243, s39
    v_perm_b32 v19, v255, v251, s39
    s_nop 1
    v_mfma_f32_16x16x32_bf16 v[188:191], v[12:15], v[16:19], 0
    v_add_f32 v160, v160, v161
    v_add_f32 v164, v164, v165
    v_add_f32 v168, v168, v169
    v_add_f32 v172, v172, v173
    v_add_f32 v176, v176, v177
    v_add_f32 v180, v180, v181
    v_add_f32 v184, v184, v185
    s_nop 0
    v_add_f32 v188, v188, v189
    v_cvt_pk_bf16_f32 v224, v160, v164
    v_cvt_pk_bf16_f32 v225, v168, v172
    v_cvt_pk_bf16_f32 v226, v176, v180
    v_cvt_pk_bf16_f32 v227, v184, v188
    s_mov_b32 exec_lo, 0xffff
    s_mov_b32 exec_hi, 0x0
    ds_write_b128 v4, v[224:227] offset:512
    s_mov_b64 exec, -1
    s_waitcnt lgkmcnt(0)
    ds_read_b128 v[192:195], v5 offset:256
    ds_read_b128 v[196:199], v5 offset:320
    ds_read_b128 v[200:203], v5 offset:384
    ds_read_b128 v[204:207], v5 offset:448
    s_lshl_b32 s62, s3, 10
    s_add_u32 s62, s62, 21504
    v_lshlrev_b32 v4, 5, v1
    v_lshl_add_u32 v4, v2, 9, v4
    v_add_u32 v4, s62, v4
    s_waitcnt lgkmcnt(0)
    v_mfma_f32_16x16x32_bf16 v[160:163], v[192:195], v[32:35], 0
    v_mfma_f32_16x16x32_bf16 v[164:167], v[192:195], v[36:39], 0
    v_mfma_f32_16x16x32_bf16 v[168:171], v[192:195], v[40:43], 0
    v_mfma_f32_16x16x32_bf16 v[172:175], v[192:195], v[44:47], 0
    v_mfma_f32_16x16x32_bf16 v[176:179], v[192:195], v[48:51], 0
    v_mfma_f32_16x16x32_bf16 v[180:183], v[192:195], v[52:55], 0
    v_mfma_f32_16x16x32_bf16 v[184:187], v[192:195], v[56:59], 0
    v_mfma_f32_16x16x32_bf16 v[188:191], v[192:195], v[60:63], 0
    v_mfma_f32_16x16x32_bf16 v[160:163], v[196:199], v[64:67], v[160:163]
    v_mfma_f32_16x16x32_bf16 v[164:167], v[196:199], v[68:71], v[164:167]
    v_mfma_f32_16x16x32_bf16 v[168:171], v[196:199], v[72:75], v[168:171]
    v_mfma_f32_16x16x32_bf16 v[172:175], v[196:199], v[76:79], v[172:175]
    v_mfma_f32_16x16x32_bf16 v[176:179], v[196:199], v[80:83], v[176:179]
    v_mfma_f32_16x16x32_bf16 v[180:183], v[196:199], v[84:87], v[180:183]
    v_mfma_f32_16x16x32_bf16 v[184:187], v[196:199], v[88:91], v[184:187]
    v_mfma_f32_16x16x32_bf16 v[188:191], v[196:199], v[92:95], v[188:191]
    v_mfma_f32_16x16x32_bf16 v[160:163], v[200:203], v[96:99], v[160:163]
    v_mfma_f32_16x16x32_bf16 v[164:167], v[200:203], v[100:103], v[164:167]
    v_mfma_f32_16x16x32_bf16 v[168:171], v[200:203], v[104:107], v[168:171]
    v_mfma_f32_16x16x32_bf16 v[172:175], v[200:203], v[108:111], v[172:175]
    v_mfma_f32_16x16x32_bf16 v[176:179], v[200:203], v[112:115], v[176:179]
    v_mfma_f32_16x16x32_bf16 v[180:183], v[200:203], v[116:119], v[180:183]
    v_mfma_f32_16x16x32_bf16 v[184:187], v[200:203], v[120:123], v[184:187]
    v_mfma_f32_16x16x32_bf16 v[188:191], v[200:203], v[124:127], v[188:191]
    v_mfma_f32_16x16x32_bf16 v[160:163], v[204:207], v[128:131], v[160:163]
    v_mfma_f32_16x16x32_bf16 v[164:167], v[204:207], v[132:135], v[164:167]
    v_mfma_f32_16x16x32_bf16 v[168:171], v[204:207], v[136:139], v[168:171]
    v_mfma_f32_16x16x32_bf16 v[172:175], v[204:207], v[140:143], v[172:175]
    v_mfma_f32_16x16x32_bf16 v[176:179], v[204:207], v[144:147], v[176:179]
    v_mfma_f32_16x16x32_bf16 v[180:183], v[204:207], v[148:151], v[180:183]
    v_mfma_f32_16x16x32_bf16 v[184:187], v[204:207], v[152:155], v[184:187]
    v_mfma_f32_16x16x32_bf16 v[188:191], v[204:207], v[156:159], v[188:191]
    s_lshl_b32 s62, s3, 15
    s_add_u32 s62, s62, 32768
    v_add_u32 v30, s62, v31
    s_mov_b32 exec_lo, 0xffffffff
    s_mov_b32 exec_hi, 0x0
    ds_write2_b32 v4, v160, v164 offset0:0 offset1:1
    ds_write2_b32 v4, v168, v172 offset0:2 offset1:3
    ds_write2_b32 v4, v176, v180 offset0:4 offset1:5
    ds_write2_b32 v4, v184, v188 offset0:6 offset1:7
    v_mov_b32 v6, 1
    v_mov_b32 v7, 16388
    s_mov_b32 exec_lo, 0x1
    s_mov_b32 exec_hi, 0x0
    ds_add_u32 v7, v6
    s_mov_b64 exec, -1
    ds_read_b128 v[32:35], v30 offset:0
    ds_read_b128 v[36:39], v30 offset:1024
    ds_read_b128 v[40:43], v30 offset:2048
    ds_read_b128 v[44:47], v30 offset:3072
    ds_read_b128 v[48:51], v30 offset:4096
    ds_read_b128 v[52:55], v30 offset:5120
    ds_read_b128 v[56:59], v30 offset:6144
    ds_read_b128 v[60:63], v30 offset:7168
    ds_read_b128 v[64:67], v30 offset:8192
    ds_read_b128 v[68:71], v30 offset:9216
    ds_read_b128 v[72:75], v30 offset:10240
    ds_read_b128 v[76:79], v30 offset:11264
    ds_read_b128 v[80:83], v30 offset:12288
    ds_read_b128 v[84:87], v30 offset:13312
    ds_read_b128 v[88:91], v30 offset:14336
    ds_read_b128 v[92:95], v30 offset:15360
    ds_read_b128 v[96:99], v30 offset:16384
    ds_read_b128 v[100:103], v30 offset:17408
    ds_read_b128 v[104:107], v30 offset:18432
    ds_read_b128 v[108:111], v30 offset:19456
    ds_read_b128 v[112:115], v30 offset:20480
    ds_read_b128 v[116:119], v30 offset:21504
    ds_read_b128 v[120:123], v30 offset:22528
    ds_read_b128 v[124:127], v30 offset:23552
    ds_read_b128 v[128:131], v30 offset:24576
    ds_read_b128 v[132:135], v30 offset:25600
    ds_read_b128 v[136:139], v30 offset:26624
    ds_read_b128 v[140:143], v30 offset:27648
    ds_read_b128 v[144:147], v30 offset:28672
    ds_read_b128 v[148:151], v30 offset:29696
    ds_read_b128 v[152:155], v30 offset:30720
    ds_read_b128 v[156:159], v30 offset:31744
    v_add_u32 v4, 21504, v31
    v_mov_b32 v7, 16388
    s_mov_b32 s52, 33554432
L_cnt_49:
    ds_read_b32 v6, v7
    s_sub_u32 s52, s52, 1
    s_cbranch_scc1 L_cntok_50
    s_waitcnt lgkmcnt(0)
    v_readfirstlane_b32 s62, v6
    s_nop 0
    s_cmp_lt_u32 s62, 4
    s_cbranch_scc1 L_cnt_49
L_cntok_50:
    ds_read_b128 v[160:163], v4 offset:0
    ds_read_b128 v[164:167], v4 offset:1024
    ds_read_b128 v[168:171], v4 offset:2048
    ds_read_b128 v[172:175], v4 offset:3072
    v_add_u32 v4, s53, v24
    s_waitcnt lgkmcnt(0)
    v_add_f32 v160, v160, v168
    v_add_f32 v161, v161, v169
    v_add_f32 v162, v162, v170
    v_add_f32 v163, v163, v171
    v_add_f32 v164, v164, v172
    v_add_f32 v165, v165, v173
    v_add_f32 v166, v166, v174
    v_add_f32 v167, v167, v175
    v_add_f32 v160, v160, v164
    v_add_f32 v161, v161, v165
    v_add_f32 v162, v162, v166
    v_add_f32 v163, v163, v167
    v_cvt_pk_bf16_f32 v8, v160, v161
    v_cvt_pk_bf16_f32 v9, v162, v163
    ds_write_b64 v4, v[8:9]
    s_waitcnt lgkmcnt(0)
    ds_read_b128 v[224:227], v5 offset:0
    ds_read_b128 v[232:235], v5 offset:64
    ds_read_b128 v[240:243], v5 offset:128
    ds_read_b128 v[248:251], v5 offset:192
    s_waitcnt lgkmcnt(0)
    v_mfma_f32_16x16x32_bf16 v[208:211], v[224:227], v[32:35], 0
    v_mfma_f32_16x16x32_bf16 v[212:215], v[224:227], v[36:39], 0
    v_mfma_f32_16x16x32_bf16 v[216:219], v[224:227], v[40:43], 0
    v_mfma_f32_16x16x32_bf16 v[220:223], v[224:227], v[44:47], 0
    v_mfma_f32_16x16x32_bf16 v[228:231], v[224:227], v[48:51], 0
    v_mfma_f32_16x16x32_bf16 v[236:239], v[224:227], v[52:55], 0
    v_mfma_f32_16x16x32_bf16 v[244:247], v[224:227], v[56:59], 0
    v_mfma_f32_16x16x32_bf16 v[252:255], v[224:227], v[60:63], 0
    v_mfma_f32_16x16x32_bf16 v[208:211], v[232:235], v[64:67], v[208:211]
    v_mfma_f32_16x16x32_bf16 v[212:215], v[232:235], v[68:71], v[212:215]
    v_mfma_f32_16x16x32_bf16 v[216:219], v[232:235], v[72:75], v[216:219]
    v_mfma_f32_16x16x32_bf16 v[220:223], v[232:235], v[76:79], v[220:223]
    v_mfma_f32_16x16x32_bf16 v[228:231], v[232:235], v[80:83], v[228:231]
    v_mfma_f32_16x16x32_bf16 v[236:239], v[232:235], v[84:87], v[236:239]
    v_mfma_f32_16x16x32_bf16 v[244:247], v[232:235], v[88:91], v[244:247]
    v_mfma_f32_16x16x32_bf16 v[252:255], v[232:235], v[92:95], v[252:255]
    v_mfma_f32_16x16x32_bf16 v[208:211], v[240:243], v[96:99], v[208:211]
    v_mfma_f32_16x16x32_bf16 v[212:215], v[240:243], v[100:103], v[212:215]
    v_mfma_f32_16x16x32_bf16 v[216:219], v[240:243], v[104:107], v[216:219]
    v_mfma_f32_16x16x32_bf16 v[220:223], v[240:243], v[108:111], v[220:223]
    v_mfma_f32_16x16x32_bf16 v[228:231], v[240:243], v[112:115], v[228:231]
    v_mfma_f32_16x16x32_bf16 v[236:239], v[240:243], v[116:119], v[236:239]
    v_mfma_f32_16x16x32_bf16 v[244:247], v[240:243], v[120:123], v[244:247]
    v_mfma_f32_16x16x32_bf16 v[252:255], v[240:243], v[124:127], v[252:255]
    v_mfma_f32_16x16x32_bf16 v[208:211], v[248:251], v[128:131], v[208:211]
    v_mfma_f32_16x16x32_bf16 v[212:215], v[248:251], v[132:135], v[212:215]
    v_mfma_f32_16x16x32_bf16 v[216:219], v[248:251], v[136:139], v[216:219]
    v_mfma_f32_16x16x32_bf16 v[220:223], v[248:251], v[140:143], v[220:223]
    v_mfma_f32_16x16x32_bf16 v[228:231], v[248:251], v[144:147], v[228:231]
    v_mfma_f32_16x16x32_bf16 v[236:239], v[248:251], v[148:151], v[236:239]
    v_mfma_f32_16x16x32_bf16 v[244:247], v[248:251], v[152:155], v[244:247]
    v_mfma_f32_16x16x32_bf16 v[252:255], v[248:251], v[156:159], v[252:255]
    s_branch L_proj
L_tailB:
    s_lshl_b32 s62, s2, 9
    s_add_u32 s40, s30, s62
    s_addc_u32 s41, s31, 0
    s_add_u32 s40, s40, 655360
    s_addc_u32 s41, s41, 0
    v_lshrrev_b32 v4, 5, v0
    v_lshlrev_b32 v5, 8, v4
    v_min_u32 v6, 15, v1
    v_lshl_add_u32 v22, v6, 4, v5
    v_cmp_gt_u32 s[98:99], 16, v1
    s_mul_i32 s62, s2, 16384
    s_and_b32 s55, s3, 3
    s_lshl_b32 s55, s55, 11
    s_add_u32 s62, s62, s55
    s_add_u32 s42, s30, s62
    s_addc_u32 s43, s31, 0
    s_add_u32 s42, s42, 720896
    s_addc_u32 s43, s43, 0
    v_mul_u32_u24 v4, 8192, v4
    v_and_b32 v5, 31, v0
    v_lshl_add_u32 v21, v5, 4, v4
    v_add_u32 v20, 0x400, v21
    s_and_b32 s62, s3, 3
    s_lshl_b32 s62, s62, 8
    s_add_u32 s62, s62, 26624
    v_lshlrev_b32 v4, 2, v0
    v_add_u32 v19, s62, v4
    v_lshrrev_b32 v4, 5, v0
    v_lshlrev_b32 v4, 7, v4
    s_and_b32 s55, s3, 3
    s_lshl_b32 s55, s55, 4
    s_lshl_b32 s63, s62, 0
    s_add_u32 s55, s55, s63
    v_add_u32 v18, s55, v4
    s_and_b32 s62, s3, 3
    s_lshl_b32 s62, s62, 9
    s_add_u32 s62, s62, 27648
    v_add_u32 v17, s62, v24
    v_and_b32 v4, 3, v1
    v_lshl_add_u32 v4, v4, 9, v25
    v_add_u32 v16, 27648, v4
    s_mov_b32 s52, 2097152
L_pp_51:
    global_load_dwordx4 v[208:211], v22, s[40:41] offset:0 sc1
    s_waitcnt vmcnt(0)
    v_perm_b32 v6, v209, v208, s48
    v_perm_b32 v7, v211, v210, s48
    v_lshl_or_b32 v6, v7, 16, v6
    v_cmp_ne_u32 s[60:61], v6, v3
    s_nop 0
    s_cmp_eq_u64 s[60:61], 0
    s_cbranch_scc1 L_ppv_53
    s_sub_u32 s52, s52, 1
    s_cbranch_scc0 L_pp_51
L_ppv_53:
    v_and_b32 v8, s50, v208
L_ppok_52:
    v_mov_b32 v9, 0xff800000
    v_cndmask_b32 v8, v9, v8, s[98:99]
    v_mov_b32 v10, v8
    s_nop 1
    v_max_f32_dpp v10, v10, v10 row_ror:8 row_mask:0xf bank_mask:0xf
    s_nop 1
    v_max_f32_dpp v10, v10, v10 row_ror:4 row_mask:0xf bank_mask:0xf
    s_nop 1
    v_max_f32_dpp v10, v10, v10 row_ror:2 row_mask:0xf bank_mask:0xf
    s_nop 1
    v_max_f32_dpp v10, v10, v10 row_ror:1 row_mask:0xf bank_mask:0xf
    v_sub_f32 v8, v8, v10
    v_exp_f32 v8, v8
    s_nop 0
    v_mov_b32 v10, v8
    s_nop 1
    v_add_f32_dpp v10, v10, v10 row_ror:8 row_mask:0xf bank_mask:0xf
    s_nop 1
    v_add_f32_dpp v10, v10, v10 row_ror:4 row_mask:0xf bank_mask:0xf
    s_nop 1
    v_add_f32_dpp v10, v10, v10 row_ror:2 row_mask:0xf bank_mask:0xf
    s_nop 1
    v_add_f32_dpp v10, v10, v10 row_ror:1 row_mask:0xf bank_mask:0xf
    v_rcp_f32 v10, v10
    s_nop 0
    v_mul_f32 v8, v8, v10
    ds_write_b32 v19, v8
    s_waitcnt lgkmcnt(0)
    ds_read_b128 v[12:15], v18
    s_mov_b32 s52, 2097152
L_pp_54:
    global_load_dwordx4 v[160:163], v21, s[42:43] offset:0 sc1
    global_load_dwordx4 v[164:167], v21, s[42:43] offset:512 sc1
    global_load_dwordx4 v[168:171], v20, s[42:43] offset:0 sc1
    global_load_dwordx4 v[172:175], v20, s[42:43] offset:512 sc1
    s_waitcnt vmcnt(0)
    v_perm_b32 v7, v163, v160, s48
    v_xor_b32 v6, s49, v7
    v_perm_b32 v7, v167, v164, s48
    v_xad_u32 v6, v7, s49, v6
    v_perm_b32 v7, v171, v168, s48
    v_xad_u32 v6, v7, s49, v6
    v_perm_b32 v7, v175, v172, s48
    v_xad_u32 v6, v7, s49, v6
    v_cmp_ne_u32 s[60:61], 0, v6
    s_nop 0
    s_cmp_eq_u64 s[60:61], 0
    s_cbranch_scc1 L_ppv_56
    s_sub_u32 s52, s52, 1
    s_cbranch_scc0 L_pp_54
L_ppv_56:
    v_and_b32 v160, s50, v160
    v_and_b32 v161, s50, v161
    v_and_b32 v162, s50, v162
    v_and_b32 v163, s50, v163
    v_and_b32 v164, s50, v164
    v_and_b32 v165, s50, v165
    v_and_b32 v166, s50, v166
    v_and_b32 v167, s50, v167
    v_and_b32 v168, s50, v168
    v_and_b32 v169, s50, v169
    v_and_b32 v170, s50, v170
    v_and_b32 v171, s50, v171
    v_and_b32 v172, s50, v172
    v_and_b32 v173, s50, v173
    v_and_b32 v174, s50, v174
    v_and_b32 v175, s50, v175
    s_waitcnt lgkmcnt(0)
    v_mul_f32 v8, v12, v160
    v_mul_f32 v9, v12, v161
    v_mul_f32 v10, v12, v162
    v_mul_f32 v11, v12, v163
    v_fmac_f32 v8, v13, v164
    v_fmac_f32 v9, v13, v165
    v_fmac_f32 v10, v13, v166
    v_fmac_f32 v11, v13, v167
    v_fmac_f32 v8, v14, v168
    v_fmac_f32 v9, v14, v169
    v_fmac_f32 v10, v14, v170
    v_fmac_f32 v11, v14, v171
    v_fmac_f32 v8, v15, v172
    v_fmac_f32 v9, v15, v173
    v_fmac_f32 v10, v15, v174
    v_fmac_f32 v11, v15, v175
L_ppok_55:
    v_cvt_pk_bf16_f32 v8, v8, v9
    v_cvt_pk_bf16_f32 v9, v10, v11
    ds_write_b64 v17, v[8:9]
    v_mov_b32 v6, 1
    v_mov_b32 v7, 29696
    s_mov_b32 exec_lo, 0x1
    s_mov_b32 exec_hi, 0x0
    ds_add_u32 v7, v6
    s_mov_b64 exec, -1
    v_mov_b32 v7, 29696
    s_mov_b32 s52, 33554432
L_cnt_57:
    ds_read_b32 v6, v7
    s_sub_u32 s52, s52, 1
    s_cbranch_scc1 L_cntok_58
    s_waitcnt lgkmcnt(0)
    v_readfirstlane_b32 s62, v6
    s_nop 0
    s_cmp_lt_u32 s62, 4
    s_cbranch_scc1 L_cnt_57
L_cntok_58:
    ds_read_b128 v[224:227], v16 offset:0
    ds_read_b128 v[232:235], v16 offset:64
    ds_read_b128 v[240:243], v16 offset:128
    ds_read_b128 v[248:251], v16 offset:192
    s_waitcnt lgkmcnt(0)
    v_mfma_f32_16x16x32_bf16 v[208:211], v[224:227], v[32:35], 0
    v_mfma_f32_16x16x32_bf16 v[208:211], v[232:235], v[64:67], v[208:211]
    v_mfma_f32_16x16x32_bf16 v[208:211], v[240:243], v[96:99], v[208:211]
    v_mfma_f32_16x16x32_bf16 v[208:211], v[248:251], v[128:131], v[208:211]
    v_mfma_f32_16x16x32_bf16 v[212:215], v[224:227], v[36:39], 0
    v_mfma_f32_16x16x32_bf16 v[212:215], v[232:235], v[68:71], v[212:215]
    v_mfma_f32_16x16x32_bf16 v[212:215], v[240:243], v[100:103], v[212:215]
    v_mfma_f32_16x16x32_bf16 v[212:215], v[248:251], v[132:135], v[212:215]
    v_mfma_f32_16x16x32_bf16 v[216:219], v[224:227], v[40:43], 0
    v_mfma_f32_16x16x32_bf16 v[216:219], v[232:235], v[72:75], v[216:219]
    s_nop 1
    v_add_f32 v208, v208, v209
    v_add_f32 v210, v210, v211
    v_add_f32 v208, v208, v210
    v_mfma_f32_16x16x32_bf16 v[216:219], v[240:243], v[104:107], v[216:219]
    v_mfma_f32_16x16x32_bf16 v[216:219], v[248:251], v[136:139], v[216:219]
    v_mfma_f32_16x16x32_bf16 v[220:223], v[224:227], v[44:47], 0
    v_mfma_f32_16x16x32_bf16 v[220:223], v[232:235], v[76:79], v[220:223]
    v_add_f32 v212, v212, v213
    v_add_f32 v214, v214, v215
    v_add_f32 v212, v212, v214
    v_mfma_f32_16x16x32_bf16 v[220:223], v[240:243], v[108:111], v[220:223]
    v_mfma_f32_16x16x32_bf16 v[220:223], v[248:251], v[140:143], v[220:223]
    v_mfma_f32_16x16x32_bf16 v[228:231], v[224:227], v[48:51], 0
    v_mfma_f32_16x16x32_bf16 v[228:231], v[232:235], v[80:83], v[228:231]
    v_add_f32 v216, v216, v217
    v_add_f32 v218, v218, v219
    v_add_f32 v216, v216, v218
    v_mfma_f32_16x16x32_bf16 v[228:231], v[240:243], v[112:115], v[228:231]
    v_mfma_f32_16x16x32_bf16 v[228:231], v[248:251], v[144:147], v[228:231]
    v_mfma_f32_16x16x32_bf16 v[236:239], v[224:227], v[52:55], 0
    v_mfma_f32_16x16x32_bf16 v[236:239], v[232:235], v[84:87], v[236:239]
    v_add_f32 v220, v220, v221
    v_add_f32 v222, v222, v223
    v_add_f32 v220, v220, v222
    v_mfma_f32_16x16x32_bf16 v[236:239], v[240:243], v[116:119], v[236:239]
    v_mfma_f32_16x16x32_bf16 v[236:239], v[248:251], v[148:151], v[236:239]
    v_mfma_f32_16x16x32_bf16 v[244:247], v[224:227], v[56:59], 0
    v_mfma_f32_16x16x32_bf16 v[244:247], v[232:235], v[88:91], v[244:247]
    v_add_f32 v228, v228, v229
    v_add_f32 v230, v230, v231
    v_add_f32 v228, v228, v230
    v_mfma_f32_16x16x32_bf16 v[244:247], v[240:243], v[120:123], v[244:247]
    v_mfma_f32_16x16x32_bf16 v[244:247], v[248:251], v[152:155], v[244:247]
    v_mfma_f32_16x16x32_bf16 v[252:255], v[224:227], v[60:63], 0
    v_mfma_f32_16x16x32_bf16 v[252:255], v[232:235], v[92:95], v[252:255]
    v_add_f32 v236, v236, v237
    v_add_f32 v238, v238, v239
    v_add_f32 v236, v236, v238
    v_mfma_f32_16x16x32_bf16 v[252:255], v[240:243], v[124:127], v[252:255]
    v_mfma_f32_16x16x32_bf16 v[252:255], v[248:251], v[156:159], v[252:255]
    s_nop 0
    v_add_f32 v244, v244, v245
    v_add_f32 v246, v246, v247
    v_add_f32 v244, v244, v246
    s_nop 3
    v_add_f32 v252, v252, v253
    v_add_f32 v254, v254, v255
    v_add_f32 v252, v252, v254
L_proj:
    s_nop 3
    v_cndmask_b32 v8, v208, v228, s[46:47]
    v_cndmask_b32 v9, v212, v236, s[46:47]
    v_cndmask_b32 v10, v216, v244, s[46:47]
    v_cndmask_b32 v11, v220, v252, s[46:47]
    v_perm_b32 v8, v8, v3, s34
    v_perm_b32 v9, v9, v3, s35
    v_perm_b32 v10, v10, v3, s36
    v_perm_b32 v11, v11, v3, s37
    global_store_dwordx4 v23, v[8:11], s[44:45] sc1
    s_and_b32 s62, s3, 3
    s_cbranch_scc1 L_fin
    s_cmp_eq_u32 s3, 0
    s_cbranch_scc1 L_fa_59
    s_mov_b32 s52, 2097152
L_pp_61:
    global_load_dwordx4 v[32:35], v31, s[86:87] offset:0 sc1
    global_load_dwordx4 v[36:39], v31, s[86:87] offset:1024 sc1
    global_load_dwordx4 v[40:43], v31, s[86:87] offset:2048 sc1
    global_load_dwordx4 v[44:47], v31, s[86:87] offset:3072 sc1
    s_waitcnt vmcnt(0)
    v_perm_b32 v7, v35, v32, s48
    v_xor_b32 v6, s49, v7
    v_perm_b32 v7, v39, v36, s48
    v_xad_u32 v6, v7, s49, v6
    v_perm_b32 v7, v43, v40, s48
    v_xad_u32 v6, v7, s49, v6
    v_perm_b32 v7, v47, v44, s48
    v_xad_u32 v6, v7, s49, v6
    v_cmp_ne_u32 s[60:61], 0, v6
    s_nop 0
    s_cmp_eq_u64 s[60:61], 0
    s_cbranch_scc1 L_ppv_63
    s_sub_u32 s52, s52, 1
    s_cbranch_scc0 L_pp_61
L_ppv_63:
    v_and_b32 v32, s50, v32
    v_and_b32 v33, s50, v33
    v_and_b32 v34, s50, v34
    v_and_b32 v35, s50, v35
    v_and_b32 v36, s50, v36
    v_and_b32 v37, s50, v37
    v_and_b32 v38, s50, v38
    v_and_b32 v39, s50, v39
    v_and_b32 v40, s50, v40
    v_and_b32 v41, s50, v41
    v_and_b32 v42, s50, v42
    v_and_b32 v43, s50, v43
    v_and_b32 v44, s50, v44
    v_and_b32 v45, s50, v45
    v_and_b32 v46, s50, v46
    v_and_b32 v47, s50, v47
    v_add_f32 v12, v32, v40
    v_add_f32 v13, v33, v41
    v_add_f32 v14, v34, v42
    v_add_f32 v15, v35, v43
    v_add_f32 v16, v36, v44
    v_add_f32 v17, v37, v45
    v_add_f32 v18, v38, v46
    v_add_f32 v19, v39, v47
L_ppok_62:
    s_branch L_fb_60
L_fa_59:
    s_mov_b32 s52, 2097152
L_pp_64:
    global_load_dwordx4 v[32:35], v31, s[86:87] offset:0 sc1
    global_load_dwordx4 v[36:39], v31, s[86:87] offset:1024 sc1
    global_load_dwordx4 v[40:43], v31, s[86:87] offset:2048 sc1
    global_load_dwordx4 v[44:47], v31, s[86:87] offset:3072 sc1
    s_waitcnt vmcnt(0)
    v_perm_b32 v7, v35, v32, s48
    v_xor_b32 v6, s49, v7
    v_perm_b32 v7, v39, v36, s48
    v_xad_u32 v6, v7, s49, v6
    v_perm_b32 v7, v43, v40, s48
    v_xad_u32 v6, v7, s49, v6
    v_perm_b32 v7, v47, v44, s48
    v_xad_u32 v6, v7, s49, v6
    v_cmp_ne_u32 s[60:61], 0, v6
    s_nop 0
    s_cmp_eq_u64 s[60:61], 0
    s_cbranch_scc1 L_ppv_66
    s_sub_u32 s52, s52, 1
    s_cbranch_scc0 L_pp_64
L_ppv_66:
    v_and_b32 v32, s50, v32
    v_and_b32 v33, s50, v33
    v_and_b32 v34, s50, v34
    v_and_b32 v35, s50, v35
    v_and_b32 v36, s50, v36
    v_and_b32 v37, s50, v37
    v_and_b32 v38, s50, v38
    v_and_b32 v39, s50, v39
    v_and_b32 v40, s50, v40
    v_and_b32 v41, s50, v41
    v_and_b32 v42, s50, v42
    v_and_b32 v43, s50, v43
    v_and_b32 v44, s50, v44
    v_and_b32 v45, s50, v45
    v_and_b32 v46, s50, v46
    v_and_b32 v47, s50, v47
    v_add_f32 v12, v32, v40
    v_add_f32 v13, v33, v41
    v_add_f32 v14, v34, v42
    v_add_f32 v15, v35, v43
    v_add_f32 v16, v36, v44
    v_add_f32 v17, v37, v45
    v_add_f32 v18, v38, v46
    v_add_f32 v19, v39, v47
L_ppok_65:
L_fb_60:
    v_add_f32 v12, v12, v16
    v_add_f32 v13, v13, v17
    v_add_f32 v14, v14, v18
    v_add_f32 v15, v15, v19
    v_permlane32_swap_b32 v12, v13
    s_nop 0
    v_permlane32_swap_b32 v14, v15
    v_add_f32 v12, v12, v13
    v_add_f32 v14, v14, v15
    s_nop 1
    v_permlane16_swap_b32 v12, v14
    v_add_f32 v12, v12, v14
    s_nop 1
    v_add_f32_dpp v12, v12, v12 row_ror:8 row_mask:0xf bank_mask:0xf
    v_cvt_pk_bf16_f32 v12, v12, v12
    s_mov_b32 exec_lo, 0xff00ff
    s_mov_b32 exec_hi, 0xff00ff
    global_store_short v27, v12, s[88:89]
    s_branch L_fin
L_roleA:
    s_sub_u32 s59, s2, 32
    s_lshl_b32 s62, s59, 18
    s_lshl_b32 s63, s3, 14
    s_add_u32 s62, s62, s63
    v_bfe_u32 v32, v0, 1, 3
    v_lshlrev_b32 v32, 11, v32
    v_lshl_add_u32 v32, v2, 5, v32
    v_and_b32 v33, 1, v0
    v_lshl_add_u32 v32, v33, 4, v32
    s_waitcnt lgkmcnt(0)
    s_add_u32 s98, s6, s62
    s_addc_u32 s99, s7, 0
    global_load_dwordx4 v[128:131], v32, s[98:99] offset:0 nt
    global_load_dwordx4 v[136:139], v32, s[98:99] offset:128 nt
    global_load_dwordx4 v[132:135], v32, s[98:99] offset:1024 nt
    global_load_dwordx4 v[140:143], v32, s[98:99] offset:1152 nt
    global_load_dwordx4 v[144:147], v32, s[98:99] offset:256 nt
    s_load_dword s32, s[30:31], 0
    s_mov_b32 s34, 0x7060500
    s_mov_b32 s35, 0x7060501
    s_mov_b32 s36, 0x7060502
    s_mov_b32 s37, 0x7060503
    s_mov_b32 s38, 0x05040100
    s_mov_b32 s39, 0x07060302
    s_mov_b32 s48, 0x0c0c0400
    s_mov_b32 s51, 0x3e0293ee
    s_mov_b32 s96, 0x55555555
    s_mov_b32 s97, 0x55555555
    s_cmp_eq_u32 s3, 1
    s_cbranch_scc0 L_skip_67
    s_and_b32 s62, s2, 7
    s_lshl_b32 s62, s62, 7
    s_lshr_b32 s63, s2, 3
    s_lshl_b32 s63, s63, 2
    s_add_u32 s62, s62, s63
    s_add_u32 s60, s30, s62
    s_addc_u32 s61, s31, 0
    s_add_u32 s60, s60, 638976
    s_addc_u32 s61, s61, 0
    s_waitcnt lgkmcnt(0)
    s_add_u32 s90, s32, 0x01010101
    s_getreg_b32 s62, hwreg(HW_REG_XCC_ID)
    s_and_b32 s62, s62, 15
    s_and_b32 s90, s90, -16
    s_or_b32 s90, s90, s62
    v_mov_b32 v246, 0
    v_mov_b32 v247, s90
    s_mov_b32 exec_lo, 0x1
    s_mov_b32 exec_hi, 0x0
    global_store_dword v246, v247, s[60:61]
    s_mov_b64 exec, -1
L_skip_67:
    s_mov_b32 s90, 0
    s_lshr_b32 s57, s59, 5
    s_and_b32 s58, s59, 31
    v_bfe_u32 v4, v1, 1, 2
    v_and_b32 v5, 3, v1
    v_lshl_add_u32 v4, v5, 2, v4
    v_lshlrev_b32 v5, 1, v2
    v_xor_b32 v4, v4, v5
    s_lshl_b32 s62, s3, 14
    v_lshlrev_b32 v5, 10, v1
    v_add_u32 v5, s62, v5
    v_lshl_add_u32 v40, v4, 4, v5
    v_xor_b32 v41, 16, v40
    v_xor_b32 v42, 128, v40
    v_xor_b32 v43, 144, v40
    s_lshl_b32 s62, s57, 15
    s_lshl_b32 s63, s3, 12
    s_add_u32 s62, s62, s63
    s_add_u32 s40, s30, s62
    s_addc_u32 s41, s31, 0
    s_add_u32 s40, s40, 393216
    s_addc_u32 s41, s41, 0
    v_lshlrev_b32 v33, 4, v0
    v_lshlrev_b32 v4, 1, v2
    v_xor_b32 v4, v4, v1
    v_lshlrev_b32 v5, 10, v1
    v_add_u32 v5, 131072, v5
    v_lshl_add_u32 v44, v4, 4, v5
    v_xor_b32 v45, 16, v44
    v_xor_b32 v46, 128, v44
    v_xor_b32 v47, 144, v44
    v_lshlrev_b32 v4, 5, v1
    v_add_u32 v35, 147456, v4
    s_lshl_b32 s62, s3, 2
    v_add_u32 v36, s62, v35
    v_and_b32 v6, 31, v0
    v_lshlrev_b32 v4, 5, v6
    v_add_u32 v37, 147456, v4
    v_lshrrev_b32 v7, 1, v2
    s_lshl_b32 s62, s3, 1
    v_add_u32 v7, s62, v7
    v_xor_b32 v7, v7, v1
    v_lshlrev_b32 v7, 4, v7
    v_lshl_add_u32 v7, v1, 9, v7
    v_and_b32 v8, 1, v2
    v_lshl_add_u32 v7, v8, 3, v7
    v_add_u32 v38, 131072, v7
    v_lshrrev_b32 v4, 5, v0
    v_xor_b32 v7, v4, v1
    v_lshlrev_b32 v7, 4, v7
    v_lshl_add_u32 v7, v6, 9, v7
    v_add_u32 v20, 131072, v7
    s_and_b32 s62, s3, 1
    s_lshl_b32 s62, s62, 3
    v_xor_b32 v7, s62, v1
    v_lshlrev_b32 v7, 4, v7
    v_lshl_add_u32 v7, v6, 10, v7
    v_lshl_add_u32 v7, v4, 3, v7
    s_lshr_b32 s62, s3, 1
    s_lshl_b32 s62, s62, 8
    s_add_u32 s62, s62, 131072
    v_add_u32 v39, s62, v7
    s_and_b32 s62, s3, 3
    s_lshl_b32 s62, s62, 2
    v_xor_b32 v7, s62, v0
    v_lshlrev_b32 v7, 4, v7
    s_lshl_b32 s62, s3, 12
    s_add_u32 s62, s62, 131072
    v_add_u32 v27, s62, v7
    v_bfe_u32 v5, v0, 2, 2
    v_lshl_add_u32 v6, v4, 3, v5
    v_lshlrev_b32 v6, 10, v6
    v_and_b32 v7, 1, v0
    v_lshl_add_u32 v6, v7, 3, v6
    s_lshr_b32 s62, s3, 1
    s_lshl_b32 s62, s62, 8
    v_add_u32 v6, s62, v6
    v_bfe_u32 v7, v0, 4, 1
    v_bfe_u32 v8, v0, 1, 1
    v_lshl_add_u32 v7, v7, 1, v8
    s_and_b32 s62, s3, 1
    s_lshl_b32 s62, s62, 3
    v_add_u32 v7, s62, v7
    v_lshrrev_b32 v8, 1, v5
    v_lshlrev_b32 v5, 2, v5
    v_xor_b32 v7, v7, v5
    v_xor_b32 v7, v7, v8
    v_xor_b32 v16, 0, v7
    v_lshl_add_u32 v16, v16, 4, v6
    v_xor_b32 v17, 2, v7
    v_lshl_add_u32 v17, v17, 4, v6
    v_add_u32 v17, 4096, v17
    v_xor_b32 v18, 4, v7
    v_lshl_add_u32 v18, v18, 4, v6
    v_xor_b32 v19, 6, v7
    v_lshl_add_u32 v19, v19, 4, v6
    v_add_u32 v19, 4096, v19
    s_and_b32 s53, s59, 15
    s_lshr_b32 s54, s59, 4
    s_add_u32 s54, s54, 10
    s_lshr_b32 s55, s59, 4
    s_lshl_b32 s55, s55, 3
    s_lshl_b32 s63, s3, 0
    s_add_u32 s55, s55, s63
    s_add_u32 s55, s55, 480
    s_lshl_b32 s62, s53, 21
    s_lshl_b32 s63, s55, 12
    s_add_u32 s62, s62, s63
    s_add_u32 s44, s18, s62
    s_addc_u32 s45, s19, 0
    s_add_u32 s46, s20, s62
    s_addc_u32 s47, s21, 0
    v_bfe_u32 v30, v0, 1, 1
    v_lshlrev_b32 v30, 11, v30
    v_bfe_u32 v31, v0, 2, 2
    v_lshl_add_u32 v30, v31, 8, v30
    v_lshl_add_u32 v30, v2, 5, v30
    v_and_b32 v31, 1, v0
    v_lshl_add_u32 v28, v31, 4, v30
    v_lshlrev_b32 v29, 4, v0
    v_lshlrev_b32 v30, 10, v2
    v_lshl_add_u32 v30, v1, 4, v30
    s_lshl_b32 s62, s3, 18
    s_lshl_b32 s63, s57, 15
    s_add_u32 s62, s62, s63
    s_lshl_b32 s63, s58, 10
    s_add_u32 s62, s62, s63
    s_add_u32 s94, s30, s62
    s_addc_u32 s95, s31, 0
    s_add_u32 s94, s94, 2097152
    s_addc_u32 s95, s95, 0
    s_lshl_b32 s62, s59, 8
    s_add_u32 s100, s30, s62
    s_addc_u32 s101, s31, 0
    s_add_u32 s100, s100, 589824
    s_addc_u32 s101, s101, 0
    s_waitcnt lgkmcnt(0)
    s_add_u32 s33, s32, 0x01010101
    v_mov_b32 v3, s33
    s_lshr_b32 s49, s33, 16
    s_and_b32 s49, s49, 0xff00
    s_and_b32 s50, s33, 0xff
    s_or_b32 s49, s49, s50
    s_mov_b32 s50, 0xffffff00
    s_getreg_b32 s62, hwreg(HW_REG_XCC_ID)
    s_and_b32 s62, s62, 15
    s_and_b32 s33, s33, -16
    s_or_b32 s33, s33, s62
    v_and_b32 v4, 3, v0
    v_lshlrev_b32 v4, 3, v4
    v_lshrrev_b32 v4, v4, v3
    v_bfe_u32 v5, v4, 1, 1
    v_bfe_u32 v80, v4, 0, 1
    v_lshl_or_b32 v80, v5, 16, v80
    v_bfe_u32 v5, v4, 3, 1
    v_bfe_u32 v81, v4, 2, 1
    v_lshl_or_b32 v81, v5, 16, v81
    v_bfe_u32 v5, v4, 5, 1
    v_bfe_u32 v82, v4, 4, 1
    v_lshl_or_b32 v82, v5, 16, v82
    v_bfe_u32 v5, v4, 7, 1
    v_bfe_u32 v83, v4, 6, 1
    v_lshl_or_b32 v83, v5, 16, v83
    global_load_dwordx4 v[152:155], v32, s[98:99] offset:384 nt
    global_load_dwordx4 v[148:151], v32, s[98:99] offset:1280 nt
    s_waitcnt vmcnt(4)
    s_mov_b64 vcc, s[96:97]
    v_cndmask_b32_dpp v124, v132, v128, vcc quad_perm:[1,0,3,2] row_mask:0xf bank_mask:0xf
    v_xor_b32 v128, v128, v124
    v_cndmask_b32_dpp v125, v133, v129, vcc quad_perm:[1,0,3,2] row_mask:0xf bank_mask:0xf
    v_xor_b32 v129, v129, v125
    v_cndmask_b32_dpp v126, v134, v130, vcc quad_perm:[1,0,3,2] row_mask:0xf bank_mask:0xf
    v_xor_b32 v130, v130, v126
    v_cndmask_b32_dpp v127, v135, v131, vcc quad_perm:[1,0,3,2] row_mask:0xf bank_mask:0xf
    v_xor_b32 v131, v131, v127
    v_xor_b32_dpp v132, v128, v132 quad_perm:[1,0,3,2] row_mask:0xf bank_mask:0xf
    v_xor_b32_dpp v133, v129, v133 quad_perm:[1,0,3,2] row_mask:0xf bank_mask:0xf
    v_xor_b32_dpp v134, v130, v134 quad_perm:[1,0,3,2] row_mask:0xf bank_mask:0xf
    v_xor_b32_dpp v135, v131, v135 quad_perm:[1,0,3,2] row_mask:0xf bank_mask:0xf
    ds_write_b128 v40, v[124:127] offset:0
    ds_write_b128 v41, v[132:135] offset:0
    global_load_dwordx4 v[156:159], v32, s[98:99] offset:1408 nt
    global_load_dwordx4 v[160:163], v32, s[98:99] offset:512 nt
    s_waitcnt vmcnt(5)
    s_mov_b64 vcc, s[96:97]
    v_cndmask_b32_dpp v128, v140, v136, vcc quad_perm:[1,0,3,2] row_mask:0xf bank_mask:0xf
    v_xor_b32 v136, v136, v128
    v_cndmask_b32_dpp v129, v141, v137, vcc quad_perm:[1,0,3,2] row_mask:0xf bank_mask:0xf
    v_xor_b32 v137, v137, v129
    v_cndmask_b32_dpp v130, v142, v138, vcc quad_perm:[1,0,3,2] row_mask:0xf bank_mask:0xf
    v_xor_b32 v138, v138, v130
    v_cndmask_b32_dpp v131, v143, v139, vcc quad_perm:[1,0,3,2] row_mask:0xf bank_mask:0xf
    v_xor_b32 v139, v139, v131
    v_xor_b32_dpp v140, v136, v140 quad_perm:[1,0,3,2] row_mask:0xf bank_mask:0xf
    v_xor_b32_dpp v141, v137, v141 quad_perm:[1,0,3,2] row_mask:0xf bank_mask:0xf
    v_xor_b32_dpp v142, v138, v142 quad_perm:[1,0,3,2] row_mask:0xf bank_mask:0xf
    v_xor_b32_dpp v143, v139, v143 quad_perm:[1,0,3,2] row_mask:0xf bank_mask:0xf
    ds_write_b128 v42, v[128:131] offset:0
    ds_write_b128 v43, v[140:143] offset:0
    global_load_dwordx4 v[168:171], v32, s[98:99] offset:640 nt
    global_load_dwordx4 v[164:167], v32, s[98:99] offset:1536 nt
    s_waitcnt vmcnt(4)
    s_mov_b64 vcc, s[96:97]
    v_cndmask_b32_dpp v136, v148, v144, vcc quad_perm:[1,0,3,2] row_mask:0xf bank_mask:0xf
    v_xor_b32 v144, v144, v136
    v_cndmask_b32_dpp v137, v149, v145, vcc quad_perm:[1,0,3,2] row_mask:0xf bank_mask:0xf
    v_xor_b32 v145, v145, v137
    v_cndmask_b32_dpp v138, v150, v146, vcc quad_perm:[1,0,3,2] row_mask:0xf bank_mask:0xf
    v_xor_b32 v146, v146, v138
    v_cndmask_b32_dpp v139, v151, v147, vcc quad_perm:[1,0,3,2] row_mask:0xf bank_mask:0xf
    v_xor_b32 v147, v147, v139
    v_xor_b32_dpp v148, v144, v148 quad_perm:[1,0,3,2] row_mask:0xf bank_mask:0xf
    v_xor_b32_dpp v149, v145, v149 quad_perm:[1,0,3,2] row_mask:0xf bank_mask:0xf
    v_xor_b32_dpp v150, v146, v150 quad_perm:[1,0,3,2] row_mask:0xf bank_mask:0xf
    v_xor_b32_dpp v151, v147, v151 quad_perm:[1,0,3,2] row_mask:0xf bank_mask:0xf
    ds_write_b128 v40, v[136:139] offset:256
    ds_write_b128 v41, v[148:151] offset:256
    global_load_dwordx4 v[172:175], v32, s[98:99] offset:1664 nt
    global_load_dwordx4 v[176:179], v32, s[98:99] offset:768 nt
    s_waitcnt vmcnt(5)
    s_mov_b64 vcc, s[96:97]
    v_cndmask_b32_dpp v144, v156, v152, vcc quad_perm:[1,0,3,2] row_mask:0xf bank_mask:0xf
    v_xor_b32 v152, v152, v144
    v_cndmask_b32_dpp v145, v157, v153, vcc quad_perm:[1,0,3,2] row_mask:0xf bank_mask:0xf
    v_xor_b32 v153, v153, v145
    v_cndmask_b32_dpp v146, v158, v154, vcc quad_perm:[1,0,3,2] row_mask:0xf bank_mask:0xf
    v_xor_b32 v154, v154, v146
    v_cndmask_b32_dpp v147, v159, v155, vcc quad_perm:[1,0,3,2] row_mask:0xf bank_mask:0xf
    v_xor_b32 v155, v155, v147
    v_xor_b32_dpp v156, v152, v156 quad_perm:[1,0,3,2] row_mask:0xf bank_mask:0xf
    v_xor_b32_dpp v157, v153, v157 quad_perm:[1,0,3,2] row_mask:0xf bank_mask:0xf
    v_xor_b32_dpp v158, v154, v158 quad_perm:[1,0,3,2] row_mask:0xf bank_mask:0xf
    v_xor_b32_dpp v159, v155, v159 quad_perm:[1,0,3,2] row_mask:0xf bank_mask:0xf
    ds_write_b128 v42, v[144:147] offset:256
    ds_write_b128 v43, v[156:159] offset:256
    global_load_dwordx4 v[184:187], v32, s[98:99] offset:896 nt
    global_load_dwordx4 v[180:183], v32, s[98:99] offset:1792 nt
    s_waitcnt vmcnt(4)
    s_mov_b64 vcc, s[96:97]
    v_cndmask_b32_dpp v152, v164, v160, vcc quad_perm:[1,0,3,2] row_mask:0xf bank_mask:0xf
    v_xor_b32 v160, v160, v152
    v_cndmask_b32_dpp v153, v165, v161, vcc quad_perm:[1,0,3,2] row_mask:0xf bank_mask:0xf
    v_xor_b32 v161, v161, v153
    v_cndmask_b32_dpp v154, v166, v162, vcc quad_perm:[1,0,3,2] row_mask:0xf bank_mask:0xf
    v_xor_b32 v162, v162, v154
    v_cndmask_b32_dpp v155, v167, v163, vcc quad_perm:[1,0,3,2] row_mask:0xf bank_mask:0xf
    v_xor_b32 v163, v163, v155
    v_xor_b32_dpp v164, v160, v164 quad_perm:[1,0,3,2] row_mask:0xf bank_mask:0xf
    v_xor_b32_dpp v165, v161, v165 quad_perm:[1,0,3,2] row_mask:0xf bank_mask:0xf
    v_xor_b32_dpp v166, v162, v166 quad_perm:[1,0,3,2] row_mask:0xf bank_mask:0xf
    v_xor_b32_dpp v167, v163, v167 quad_perm:[1,0,3,2] row_mask:0xf bank_mask:0xf
    ds_write_b128 v40, v[152:155] offset:512
    ds_write_b128 v41, v[164:167] offset:512
    global_load_dwordx4 v[188:191], v32, s[98:99] offset:1920 nt
    s_add_u32 s98, s98, 131072
    s_addc_u32 s99, s99, 0
    global_load_dwordx4 v[192:195], v32, s[98:99] offset:0 nt
    s_waitcnt vmcnt(5)
    s_mov_b64 vcc, s[96:97]
    v_cndmask_b32_dpp v160, v172, v168, vcc quad_perm:[1,0,3,2] row_mask:0xf bank_mask:0xf
    v_xor_b32 v168, v168, v160
    v_cndmask_b32_dpp v161, v173, v169, vcc quad_perm:[1,0,3,2] row_mask:0xf bank_mask:0xf
    v_xor_b32 v169, v169, v161
    v_cndmask_b32_dpp v162, v174, v170, vcc quad_perm:[1,0,3,2] row_mask:0xf bank_mask:0xf
    v_xor_b32 v170, v170, v162
    v_cndmask_b32_dpp v163, v175, v171, vcc quad_perm:[1,0,3,2] row_mask:0xf bank_mask:0xf
    v_xor_b32 v171, v171, v163
    v_xor_b32_dpp v172, v168, v172 quad_perm:[1,0,3,2] row_mask:0xf bank_mask:0xf
    v_xor_b32_dpp v173, v169, v173 quad_perm:[1,0,3,2] row_mask:0xf bank_mask:0xf
    v_xor_b32_dpp v174, v170, v174 quad_perm:[1,0,3,2] row_mask:0xf bank_mask:0xf
    v_xor_b32_dpp v175, v171, v175 quad_perm:[1,0,3,2] row_mask:0xf bank_mask:0xf
    ds_write_b128 v42, v[160:163] offset:512
    ds_write_b128 v43, v[172:175] offset:512
    global_load_dwordx4 v[200:203], v32, s[98:99] offset:128 nt
    global_load_dwordx4 v[196:199], v32, s[98:99] offset:1024 nt
    s_waitcnt vmcnt(4)
    s_mov_b64 vcc, s[96:97]
    v_cndmask_b32_dpp v168, v180, v176, vcc quad_perm:[1,0,3,2] row_mask:0xf bank_mask:0xf
    v_xor_b32 v176, v176, v168
    v_cndmask_b32_dpp v169, v181, v177, vcc quad_perm:[1,0,3,2] row_mask:0xf bank_mask:0xf
    v_xor_b32 v177, v177, v169
    v_cndmask_b32_dpp v170, v182, v178, vcc quad_perm:[1,0,3,2] row_mask:0xf bank_mask:0xf
    v_xor_b32 v178, v178, v170
    v_cndmask_b32_dpp v171, v183, v179, vcc quad_perm:[1,0,3,2] row_mask:0xf bank_mask:0xf
    v_xor_b32 v179, v179, v171
    v_xor_b32_dpp v180, v176, v180 quad_perm:[1,0,3,2] row_mask:0xf bank_mask:0xf
    v_xor_b32_dpp v181, v177, v181 quad_perm:[1,0,3,2] row_mask:0xf bank_mask:0xf
    v_xor_b32_dpp v182, v178, v182 quad_perm:[1,0,3,2] row_mask:0xf bank_mask:0xf
    v_xor_b32_dpp v183, v179, v183 quad_perm:[1,0,3,2] row_mask:0xf bank_mask:0xf
    ds_write_b128 v40, v[168:171] offset:768
    ds_write_b128 v41, v[180:183] offset:768
    global_load_dwordx4 v[204:207], v32, s[98:99] offset:1152 nt
    global_load_dwordx4 v[208:211], v32, s[98:99] offset:256 nt
    s_waitcnt vmcnt(5)
    s_mov_b64 vcc, s[96:97]
    v_cndmask_b32_dpp v176, v188, v184, vcc quad_perm:[1,0,3,2] row_mask:0xf bank_mask:0xf
    v_xor_b32 v184, v184, v176
    v_cndmask_b32_dpp v177, v189, v185, vcc quad_perm:[1,0,3,2] row_mask:0xf bank_mask:0xf
    v_xor_b32 v185, v185, v177
    v_cndmask_b32_dpp v178, v190, v186, vcc quad_perm:[1,0,3,2] row_mask:0xf bank_mask:0xf
    v_xor_b32 v186, v186, v178
    v_cndmask_b32_dpp v179, v191, v187, vcc quad_perm:[1,0,3,2] row_mask:0xf bank_mask:0xf
    v_xor_b32 v187, v187, v179
    v_xor_b32_dpp v188, v184, v188 quad_perm:[1,0,3,2] row_mask:0xf bank_mask:0xf
    v_xor_b32_dpp v189, v185, v189 quad_perm:[1,0,3,2] row_mask:0xf bank_mask:0xf
    v_xor_b32_dpp v190, v186, v190 quad_perm:[1,0,3,2] row_mask:0xf bank_mask:0xf
    v_xor_b32_dpp v191, v187, v191 quad_perm:[1,0,3,2] row_mask:0xf bank_mask:0xf
    ds_write_b128 v42, v[176:179] offset:768
    ds_write_b128 v43, v[188:191] offset:768
    global_load_dwordx4 v[216:219], v32, s[98:99] offset:384 nt
    global_load_dwordx4 v[212:215], v32, s[98:99] offset:1280 nt
    s_waitcnt vmcnt(4)
    s_mov_b64 vcc, s[96:97]
    v_cndmask_b32_dpp v184, v196, v192, vcc quad_perm:[1,0,3,2] row_mask:0xf bank_mask:0xf
    v_xor_b32 v192, v192, v184
    v_cndmask_b32_dpp v185, v197, v193, vcc quad_perm:[1,0,3,2] row_mask:0xf bank_mask:0xf
    v_xor_b32 v193, v193, v185
    v_cndmask_b32_dpp v186, v198, v194, vcc quad_perm:[1,0,3,2] row_mask:0xf bank_mask:0xf
    v_xor_b32 v194, v194, v186
    v_cndmask_b32_dpp v187, v199, v195, vcc quad_perm:[1,0,3,2] row_mask:0xf bank_mask:0xf
    v_xor_b32 v195, v195, v187
    v_xor_b32_dpp v196, v192, v196 quad_perm:[1,0,3,2] row_mask:0xf bank_mask:0xf
    v_xor_b32_dpp v197, v193, v197 quad_perm:[1,0,3,2] row_mask:0xf bank_mask:0xf
    v_xor_b32_dpp v198, v194, v198 quad_perm:[1,0,3,2] row_mask:0xf bank_mask:0xf
    v_xor_b32_dpp v199, v195, v199 quad_perm:[1,0,3,2] row_mask:0xf bank_mask:0xf
    global_load_dwordx4 v[220:223], v32, s[98:99] offset:1408 nt
    global_load_dwordx4 v[224:227], v32, s[98:99] offset:512 nt
    s_waitcnt vmcnt(5)
    s_mov_b64 vcc, s[96:97]
    v_cndmask_b32_dpp v192, v204, v200, vcc quad_perm:[1,0,3,2] row_mask:0xf bank_mask:0xf
    v_xor_b32 v200, v200, v192
    v_cndmask_b32_dpp v193, v205, v201, vcc quad_perm:[1,0,3,2] row_mask:0xf bank_mask:0xf
    v_xor_b32 v201, v201, v193
    v_cndmask_b32_dpp v194, v206, v202, vcc quad_perm:[1,0,3,2] row_mask:0xf bank_mask:0xf
    v_xor_b32 v202, v202, v194
    v_cndmask_b32_dpp v195, v207, v203, vcc quad_perm:[1,0,3,2] row_mask:0xf bank_mask:0xf
    v_xor_b32 v203, v203, v195
    v_xor_b32_dpp v204, v200, v204 quad_perm:[1,0,3,2] row_mask:0xf bank_mask:0xf
    v_xor_b32_dpp v205, v201, v205 quad_perm:[1,0,3,2] row_mask:0xf bank_mask:0xf
    v_xor_b32_dpp v206, v202, v206 quad_perm:[1,0,3,2] row_mask:0xf bank_mask:0xf
    v_xor_b32_dpp v207, v203, v207 quad_perm:[1,0,3,2] row_mask:0xf bank_mask:0xf
    global_load_dwordx4 v[232:235], v32, s[98:99] offset:640 nt
    global_load_dwordx4 v[228:231], v32, s[98:99] offset:1536 nt
    global_load_dwordx4 v[64:67], v33, s[40:41] offset:0 sc1
    global_load_dwordx4 v[68:71], v33, s[40:41] offset:1024 sc1
    global_load_dwordx4 v[72:75], v33, s[40:41] offset:2048 sc1
    global_load_dwordx4 v[76:79], v33, s[40:41] offset:3072 sc1
    s_waitcnt vmcnt(8)
    s_mov_b64 vcc, s[96:97]
    v_cndmask_b32_dpp v200, v212, v208, vcc quad_perm:[1,0,3,2] row_mask:0xf bank_mask:0xf
    v_xor_b32 v208, v208, v200
    v_cndmask_b32_dpp v201, v213, v209, vcc quad_perm:[1,0,3,2] row_mask:0xf bank_mask:0xf
    v_xor_b32 v209, v209, v201
    v_cndmask_b32_dpp v202, v214, v210, vcc quad_perm:[1,0,3,2] row_mask:0xf bank_mask:0xf
    v_xor_b32 v210, v210, v202
    v_cndmask_b32_dpp v203, v215, v211, vcc quad_perm:[1,0,3,2] row_mask:0xf bank_mask:0xf
    v_xor_b32 v211, v211, v203
    v_xor_b32_dpp v212, v208, v212 quad_perm:[1,0,3,2] row_mask:0xf bank_mask:0xf
    v_xor_b32_dpp v213, v209, v213 quad_perm:[1,0,3,2] row_mask:0xf bank_mask:0xf
    v_xor_b32_dpp v214, v210, v214 quad_perm:[1,0,3,2] row_mask:0xf bank_mask:0xf
    v_xor_b32_dpp v215, v211, v215 quad_perm:[1,0,3,2] row_mask:0xf bank_mask:0xf
    global_load_dwordx4 v[236:239], v32, s[98:99] offset:1664 nt
    global_load_dwordx4 v[240:243], v32, s[98:99] offset:768 nt
    s_waitcnt vmcnt(9)
    s_mov_b64 vcc, s[96:97]
    v_cndmask_b32_dpp v208, v220, v216, vcc quad_perm:[1,0,3,2] row_mask:0xf bank_mask:0xf
    v_xor_b32 v216, v216, v208
    v_cndmask_b32_dpp v209, v221, v217, vcc quad_perm:[1,0,3,2] row_mask:0xf bank_mask:0xf
    v_xor_b32 v217, v217, v209
    v_cndmask_b32_dpp v210, v222, v218, vcc quad_perm:[1,0,3,2] row_mask:0xf bank_mask:0xf
    v_xor_b32 v218, v218, v210
    v_cndmask_b32_dpp v211, v223, v219, vcc quad_perm:[1,0,3,2] row_mask:0xf bank_mask:0xf
    v_xor_b32 v219, v219, v211
    v_xor_b32_dpp v220, v216, v220 quad_perm:[1,0,3,2] row_mask:0xf bank_mask:0xf
    v_xor_b32_dpp v221, v217, v221 quad_perm:[1,0,3,2] row_mask:0xf bank_mask:0xf
    v_xor_b32_dpp v222, v218, v222 quad_perm:[1,0,3,2] row_mask:0xf bank_mask:0xf
    v_xor_b32_dpp v223, v219, v223 quad_perm:[1,0,3,2] row_mask:0xf bank_mask:0xf
    global_load_dwordx4 v[248:251], v32, s[98:99] offset:896 nt
    global_load_dwordx4 v[244:247], v32, s[98:99] offset:1792 nt
    s_waitcnt vmcnt(8)
    s_mov_b64 vcc, s[96:97]
    v_cndmask_b32_dpp v216, v228, v224, vcc quad_perm:[1,0,3,2] row_mask:0xf bank_mask:0xf
    v_xor_b32 v224, v224, v216
    v_cndmask_b32_dpp v217, v229, v225, vcc quad_perm:[1,0,3,2] row_mask:0xf bank_mask:0xf
    v_xor_b32 v225, v225, v217
    v_cndmask_b32_dpp v218, v230, v226, vcc quad_perm:[1,0,3,2] row_mask:0xf bank_mask:0xf
    v_xor_b32 v226, v226, v218
    v_cndmask_b32_dpp v219, v231, v227, vcc quad_perm:[1,0,3,2] row_mask:0xf bank_mask:0xf
    v_xor_b32 v227, v227, v219
    v_xor_b32_dpp v228, v224, v228 quad_perm:[1,0,3,2] row_mask:0xf bank_mask:0xf
    v_xor_b32_dpp v229, v225, v229 quad_perm:[1,0,3,2] row_mask:0xf bank_mask:0xf
    v_xor_b32_dpp v230, v226, v230 quad_perm:[1,0,3,2] row_mask:0xf bank_mask:0xf
    v_xor_b32_dpp v231, v227, v231 quad_perm:[1,0,3,2] row_mask:0xf bank_mask:0xf
    global_load_dwordx4 v[252:255], v32, s[98:99] offset:1920 nt
    s_mov_b32 s92, 0
    s_mov_b32 s52, 2097152
    s_waitcnt vmcnt(5)
    s_branch L_qachk_69
L_qa_68:
    s_sub_u32 s52, s52, 1
    s_cbranch_scc1 L_qaok_70
    s_bitcmp1_b32 s92, 0
    s_cbranch_scc1 L_qsk_71
    global_load_dwordx4 v[64:67], v33, s[40:41] offset:0 sc1
L_qsk_71:
    s_bitcmp1_b32 s92, 1
    s_cbranch_scc1 L_qsk_72
    global_load_dwordx4 v[68:71], v33, s[40:41] offset:1024 sc1
L_qsk_72:
    s_bitcmp1_b32 s92, 2
    s_cbranch_scc1 L_qsk_73
    global_load_dwordx4 v[72:75], v33, s[40:41] offset:2048 sc1
L_qsk_73:
    s_bitcmp1_b32 s92, 3
    s_cbranch_scc1 L_qsk_74
    global_load_dwordx4 v[76:79], v33, s[40:41] offset:3072 sc1
L_qsk_74:
    s_waitcnt vmcnt(0)
L_qachk_69:
    v_xor_b32 v4, v64, v80
    v_xor_b32 v5, v65, v81
    v_xor_b32 v6, v66, v82
    v_xor_b32 v7, v67, v83
    v_or3_b32 v4, v4, v5, v6
    v_or_b32 v4, v4, v7
    v_and_b32 v4, 0x10001, v4
    v_cmp_ne_u32 s[60:61], 0, v4
    s_nop 0
    s_cmp_eq_u64 s[60:61], 0
    s_cselect_b32 s62, 1, 0
    s_or_b32 s92, s92, s62
    v_xor_b32 v4, v68, v80
    v_xor_b32 v5, v69, v81
    v_xor_b32 v6, v70, v82
    v_xor_b32 v7, v71, v83
    v_or3_b32 v4, v4, v5, v6
    v_or_b32 v4, v4, v7
    v_and_b32 v4, 0x10001, v4
    v_cmp_ne_u32 s[60:61], 0, v4
    s_nop 0
    s_cmp_eq_u64 s[60:61], 0
    s_cselect_b32 s62, 2, 0
    s_or_b32 s92, s92, s62
    v_xor_b32 v4, v72, v80
    v_xor_b32 v5, v73, v81
    v_xor_b32 v6, v74, v82
    v_xor_b32 v7, v75, v83
    v_or3_b32 v4, v4, v5, v6
    v_or_b32 v4, v4, v7
    v_and_b32 v4, 0x10001, v4
    v_cmp_ne_u32 s[60:61], 0, v4
    s_nop 0
    s_cmp_eq_u64 s[60:61], 0
    s_cselect_b32 s62, 4, 0
    s_or_b32 s92, s92, s62
    v_xor_b32 v4, v76, v80
    v_xor_b32 v5, v77, v81
    v_xor_b32 v6, v78, v82
    v_xor_b32 v7, v79, v83
    v_or3_b32 v4, v4, v5, v6
    v_or_b32 v4, v4, v7
    v_and_b32 v4, 0x10001, v4
    v_cmp_ne_u32 s[60:61], 0, v4
    s_nop 0
    s_cmp_eq_u64 s[60:61], 0
    s_cselect_b32 s62, 8, 0
    s_or_b32 s92, s92, s62
    s_cmp_lg_u32 s92, 15
    s_cbranch_scc1 L_qa_68
L_qaok_70:
    v_xor_b32 v64, v64, v80
    v_xor_b32 v65, v65, v81
    v_xor_b32 v66, v66, v82
    v_xor_b32 v67, v67, v83
    v_xor_b32 v4, 0, v27
    ds_write_b128 v4, v[64:67] offset:0
    v_xor_b32 v68, v68, v80
    v_xor_b32 v69, v69, v81
    v_xor_b32 v70, v70, v82
    v_xor_b32 v71, v71, v83
    v_xor_b32 v5, 16, v27
    ds_write_b128 v5, v[68:71] offset:1024
    v_xor_b32 v72, v72, v80
    v_xor_b32 v73, v73, v81
    v_xor_b32 v74, v74, v82
    v_xor_b32 v75, v75, v83
    v_xor_b32 v6, 32, v27
    ds_write_b128 v6, v[72:75] offset:2048
    v_xor_b32 v76, v76, v80
    v_xor_b32 v77, v77, v81
    v_xor_b32 v78, v78, v82
    v_xor_b32 v79, v79, v83
    v_xor_b32 v7, 48, v27
    ds_write_b128 v7, v[76:79] offset:3072
    s_waitcnt lgkmcnt(0)
    s_barrier
    ds_read_b128 v[64:67], v44 offset:0
    ds_read_b128 v[68:71], v44 offset:16384
    ds_read_b128 v[72:75], v45 offset:0
    ds_read_b128 v[76:79], v45 offset:16384
    ds_read_b128 v[80:83], v46 offset:0
    ds_read_b128 v[84:87], v46 offset:16384
    ds_read_b128 v[88:91], v47 offset:0
    ds_read_b128 v[92:95], v47 offset:16384
    s_waitcnt lgkmcnt(6)
    v_mfma_f32_16x16x32_bf16 v[48:51], v[124:127], v[64:67], 0
    v_mfma_f32_16x16x32_bf16 v[52:55], v[184:187], v[64:67], 0
    v_mfma_f32_16x16x32_bf16 v[56:59], v[124:127], v[68:71], 0
    v_mfma_f32_16x16x32_bf16 v[60:63], v[184:187], v[68:71], 0
    ds_read_b128 v[64:67], v44 offset:256
    ds_read_b128 v[68:71], v44 offset:16640
    s_waitcnt lgkmcnt(6)
    v_mfma_f32_16x16x32_bf16 v[48:51], v[132:135], v[72:75], v[48:51]
    v_mfma_f32_16x16x32_bf16 v[52:55], v[196:199], v[72:75], v[52:55]
    v_mfma_f32_16x16x32_bf16 v[56:59], v[132:135], v[76:79], v[56:59]
    v_mfma_f32_16x16x32_bf16 v[60:63], v[196:199], v[76:79], v[60:63]
    ds_read_b128 v[72:75], v45 offset:256
    ds_read_b128 v[76:79], v45 offset:16640
    s_waitcnt lgkmcnt(6)
    v_mfma_f32_16x16x32_bf16 v[48:51], v[128:131], v[80:83], v[48:51]
    v_mfma_f32_16x16x32_bf16 v[52:55], v[192:195], v[80:83], v[52:55]
    v_mfma_f32_16x16x32_bf16 v[56:59], v[128:131], v[84:87], v[56:59]
    v_mfma_f32_16x16x32_bf16 v[60:63], v[192:195], v[84:87], v[60:63]
    ds_read_b128 v[80:83], v46 offset:256
    ds_read_b128 v[84:87], v46 offset:16640
    s_waitcnt lgkmcnt(6)
    v_mfma_f32_16x16x32_bf16 v[48:51], v[140:143], v[88:91], v[48:51]
    v_mfma_f32_16x16x32_bf16 v[52:55], v[204:207], v[88:91], v[52:55]
    v_mfma_f32_16x16x32_bf16 v[56:59], v[140:143], v[92:95], v[56:59]
    v_mfma_f32_16x16x32_bf16 v[60:63], v[204:207], v[92:95], v[60:63]
    ds_read_b128 v[88:91], v47 offset:256
    ds_read_b128 v[92:95], v47 offset:16640
    s_waitcnt lgkmcnt(6)
    v_mfma_f32_16x16x32_bf16 v[48:51], v[136:139], v[64:67], v[48:51]
    v_mfma_f32_16x16x32_bf16 v[52:55], v[200:203], v[64:67], v[52:55]
    v_mfma_f32_16x16x32_bf16 v[56:59], v[136:139], v[68:71], v[56:59]
    v_mfma_f32_16x16x32_bf16 v[60:63], v[200:203], v[68:71], v[60:63]
    ds_read_b128 v[64:67], v44 offset:512
    ds_read_b128 v[68:71], v44 offset:16896
    s_waitcnt lgkmcnt(6)
    v_mfma_f32_16x16x32_bf16 v[48:51], v[148:151], v[72:75], v[48:51]
    v_mfma_f32_16x16x32_bf16 v[52:55], v[212:215], v[72:75], v[52:55]
    v_mfma_f32_16x16x32_bf16 v[56:59], v[148:151], v[76:79], v[56:59]
    v_mfma_f32_16x16x32_bf16 v[60:63], v[212:215], v[76:79], v[60:63]
    ds_read_b128 v[72:75], v45 offset:512
    ds_read_b128 v[76:79], v45 offset:16896
    s_waitcnt lgkmcnt(6)
    v_mfma_f32_16x16x32_bf16 v[48:51], v[144:147], v[80:83], v[48:51]
    v_mfma_f32_16x16x32_bf16 v[52:55], v[208:211], v[80:83], v[52:55]
    v_mfma_f32_16x16x32_bf16 v[56:59], v[144:147], v[84:87], v[56:59]
    v_mfma_f32_16x16x32_bf16 v[60:63], v[208:211], v[84:87], v[60:63]
    ds_read_b128 v[80:83], v46 offset:512
    ds_read_b128 v[84:87], v46 offset:16896
    s_waitcnt lgkmcnt(6)
    v_mfma_f32_16x16x32_bf16 v[48:51], v[156:159], v[88:91], v[48:51]
    v_mfma_f32_16x16x32_bf16 v[52:55], v[220:223], v[88:91], v[52:55]
    v_mfma_f32_16x16x32_bf16 v[56:59], v[156:159], v[92:95], v[56:59]
    v_mfma_f32_16x16x32_bf16 v[60:63], v[220:223], v[92:95], v[60:63]
    ds_read_b128 v[88:91], v47 offset:512
    ds_read_b128 v[92:95], v47 offset:16896
    s_waitcnt lgkmcnt(6)
    v_mfma_f32_16x16x32_bf16 v[48:51], v[152:155], v[64:67], v[48:51]
    v_mfma_f32_16x16x32_bf16 v[52:55], v[216:219], v[64:67], v[52:55]
    v_mfma_f32_16x16x32_bf16 v[56:59], v[152:155], v[68:71], v[56:59]
    v_mfma_f32_16x16x32_bf16 v[60:63], v[216:219], v[68:71], v[60:63]
    ds_read_b128 v[64:67], v44 offset:768
    ds_read_b128 v[68:71], v44 offset:17152
    s_waitcnt lgkmcnt(6)
    v_mfma_f32_16x16x32_bf16 v[48:51], v[164:167], v[72:75], v[48:51]
    v_mfma_f32_16x16x32_bf16 v[52:55], v[228:231], v[72:75], v[52:55]
    v_mfma_f32_16x16x32_bf16 v[56:59], v[164:167], v[76:79], v[56:59]
    v_mfma_f32_16x16x32_bf16 v[60:63], v[228:231], v[76:79], v[60:63]
    ds_read_b128 v[72:75], v45 offset:768
    ds_read_b128 v[76:79], v45 offset:17152
    s_waitcnt vmcnt(4)
    s_mov_b64 vcc, s[96:97]
    v_cndmask_b32_dpp v224, v236, v232, vcc quad_perm:[1,0,3,2] row_mask:0xf bank_mask:0xf
    v_xor_b32 v232, v232, v224
    v_cndmask_b32_dpp v225, v237, v233, vcc quad_perm:[1,0,3,2] row_mask:0xf bank_mask:0xf
    v_xor_b32 v233, v233, v225
    v_cndmask_b32_dpp v226, v238, v234, vcc quad_perm:[1,0,3,2] row_mask:0xf bank_mask:0xf
    v_xor_b32 v234, v234, v226
    v_cndmask_b32_dpp v227, v239, v235, vcc quad_perm:[1,0,3,2] row_mask:0xf bank_mask:0xf
    v_xor_b32 v235, v235, v227
    v_xor_b32_dpp v236, v232, v236 quad_perm:[1,0,3,2] row_mask:0xf bank_mask:0xf
    v_xor_b32_dpp v237, v233, v237 quad_perm:[1,0,3,2] row_mask:0xf bank_mask:0xf
    v_xor_b32_dpp v238, v234, v238 quad_perm:[1,0,3,2] row_mask:0xf bank_mask:0xf
    v_xor_b32_dpp v239, v235, v239 quad_perm:[1,0,3,2] row_mask:0xf bank_mask:0xf
    s_waitcnt lgkmcnt(6)
    v_mfma_f32_16x16x32_bf16 v[48:51], v[160:163], v[80:83], v[48:51]
    v_mfma_f32_16x16x32_bf16 v[52:55], v[224:227], v[80:83], v[52:55]
    v_mfma_f32_16x16x32_bf16 v[56:59], v[160:163], v[84:87], v[56:59]
    v_mfma_f32_16x16x32_bf16 v[60:63], v[224:227], v[84:87], v[60:63]
    ds_read_b128 v[80:83], v46 offset:768
    ds_read_b128 v[84:87], v46 offset:17152
    s_waitcnt lgkmcnt(6)
    v_mfma_f32_16x16x32_bf16 v[48:51], v[172:175], v[88:91], v[48:51]
    v_mfma_f32_16x16x32_bf16 v[52:55], v[236:239], v[88:91], v[52:55]
    v_mfma_f32_16x16x32_bf16 v[56:59], v[172:175], v[92:95], v[56:59]
    v_mfma_f32_16x16x32_bf16 v[60:63], v[236:239], v[92:95], v[60:63]
    ds_read_b128 v[88:91], v47 offset:768
    ds_read_b128 v[92:95], v47 offset:17152
    s_waitcnt vmcnt(1)
    s_mov_b64 vcc, s[96:97]
    v_cndmask_b32_dpp v232, v244, v240, vcc quad_perm:[1,0,3,2] row_mask:0xf bank_mask:0xf
    v_xor_b32 v240, v240, v232
    v_cndmask_b32_dpp v233, v245, v241, vcc quad_perm:[1,0,3,2] row_mask:0xf bank_mask:0xf
    v_xor_b32 v241, v241, v233
    v_cndmask_b32_dpp v234, v246, v242, vcc quad_perm:[1,0,3,2] row_mask:0xf bank_mask:0xf
    v_xor_b32 v242, v242, v234
    v_cndmask_b32_dpp v235, v247, v243, vcc quad_perm:[1,0,3,2] row_mask:0xf bank_mask:0xf
    v_xor_b32 v243, v243, v235
    v_xor_b32_dpp v244, v240, v244 quad_perm:[1,0,3,2] row_mask:0xf bank_mask:0xf
    v_xor_b32_dpp v245, v241, v245 quad_perm:[1,0,3,2] row_mask:0xf bank_mask:0xf
    v_xor_b32_dpp v246, v242, v246 quad_perm:[1,0,3,2] row_mask:0xf bank_mask:0xf
    v_xor_b32_dpp v247, v243, v247 quad_perm:[1,0,3,2] row_mask:0xf bank_mask:0xf
    s_waitcnt lgkmcnt(6)
    v_mfma_f32_16x16x32_bf16 v[48:51], v[168:171], v[64:67], v[48:51]
    v_mfma_f32_16x16x32_bf16 v[52:55], v[232:235], v[64:67], v[52:55]
    v_mfma_f32_16x16x32_bf16 v[56:59], v[168:171], v[68:71], v[56:59]
    v_mfma_f32_16x16x32_bf16 v[60:63], v[232:235], v[68:71], v[60:63]
    s_waitcnt lgkmcnt(4)
    v_mfma_f32_16x16x32_bf16 v[48:51], v[180:183], v[72:75], v[48:51]
    v_mfma_f32_16x16x32_bf16 v[52:55], v[244:247], v[72:75], v[52:55]
    v_mfma_f32_16x16x32_bf16 v[56:59], v[180:183], v[76:79], v[56:59]
    v_mfma_f32_16x16x32_bf16 v[60:63], v[244:247], v[76:79], v[60:63]
    s_waitcnt vmcnt(0)
    s_mov_b64 vcc, s[96:97]
    v_cndmask_b32_dpp v240, v252, v248, vcc quad_perm:[1,0,3,2] row_mask:0xf bank_mask:0xf
    v_xor_b32 v248, v248, v240
    v_cndmask_b32_dpp v241, v253, v249, vcc quad_perm:[1,0,3,2] row_mask:0xf bank_mask:0xf
    v_xor_b32 v249, v249, v241
    v_cndmask_b32_dpp v242, v254, v250, vcc quad_perm:[1,0,3,2] row_mask:0xf bank_mask:0xf
    v_xor_b32 v250, v250, v242
    v_cndmask_b32_dpp v243, v255, v251, vcc quad_perm:[1,0,3,2] row_mask:0xf bank_mask:0xf
    v_xor_b32 v251, v251, v243
    v_xor_b32_dpp v252, v248, v252 quad_perm:[1,0,3,2] row_mask:0xf bank_mask:0xf
    v_xor_b32_dpp v253, v249, v253 quad_perm:[1,0,3,2] row_mask:0xf bank_mask:0xf
    v_xor_b32_dpp v254, v250, v254 quad_perm:[1,0,3,2] row_mask:0xf bank_mask:0xf
    v_xor_b32_dpp v255, v251, v255 quad_perm:[1,0,3,2] row_mask:0xf bank_mask:0xf
    s_waitcnt lgkmcnt(2)
    v_mfma_f32_16x16x32_bf16 v[48:51], v[176:179], v[80:83], v[48:51]
    v_mfma_f32_16x16x32_bf16 v[52:55], v[240:243], v[80:83], v[52:55]
    v_mfma_f32_16x16x32_bf16 v[56:59], v[176:179], v[84:87], v[56:59]
    v_mfma_f32_16x16x32_bf16 v[60:63], v[240:243], v[84:87], v[60:63]
    s_waitcnt lgkmcnt(0)
    v_mfma_f32_16x16x32_bf16 v[48:51], v[188:191], v[88:91], v[48:51]
    v_mfma_f32_16x16x32_bf16 v[52:55], v[252:255], v[88:91], v[52:55]
    v_mfma_f32_16x16x32_bf16 v[56:59], v[188:191], v[92:95], v[56:59]
    v_mfma_f32_16x16x32_bf16 v[60:63], v[252:255], v[92:95], v[60:63]
    global_load_dwordx4 v[128:131], v28, s[44:45] offset:0 nt
    global_load_dwordx4 v[136:139], v28, s[44:45] offset:128 nt
    s_nop 2
    v_max3_f32 v4, v48, v49, v50
    v_max3_f32 v4, v4, v51, v52
    v_max3_f32 v4, v4, v53, v54
    v_max_f32 v4, v4, v55
    v_max3_f32 v5, v56, v57, v58
    v_max3_f32 v5, v5, v59, v60
    v_max3_f32 v5, v5, v61, v62
    v_max_f32 v5, v5, v63
    v_mov_b32 v6, v4
    v_mov_b32 v7, v5
    s_nop 0
    v_permlane16_swap_b32 v6, v4
    v_permlane16_swap_b32 v7, v5
    v_max_f32 v4, v4, v6
    v_max_f32 v5, v5, v7
    v_mov_b32 v6, v4
    v_mov_b32 v7, v5
    s_nop 0
    v_permlane32_swap_b32 v6, v4
    v_permlane32_swap_b32 v7, v5
    v_max_f32 v4, v4, v6
    v_max_f32 v5, v5, v7
    s_waitcnt lgkmcnt(0)
    s_barrier
    s_mov_b32 exec_lo, 0xffff
    s_mov_b32 exec_hi, 0x0
    ds_write_b32 v36, v4 offset:0
    ds_write_b32 v36, v5 offset:512
    s_mov_b64 exec, -1
    global_load_dwordx4 v[132:135], v28, s[44:45] offset:1024 nt
    global_load_dwordx4 v[140:143], v28, s[44:45] offset:1152 nt
    s_add_u32 s44, s44, 4096
    s_addc_u32 s45, s45, 0
    s_waitcnt lgkmcnt(0)
    s_barrier
    ds_read_b128 v[64:67], v35 offset:0
    ds_read_b128 v[68:71], v35 offset:16
    ds_read_b128 v[72:75], v35 offset:512
    ds_read_b128 v[76:79], v35 offset:528
    ds_read_b128 v[80:83], v37 offset:0
    ds_read_b128 v[84:87], v37 offset:16
    s_waitcnt lgkmcnt(0)
    v_max3_f32 v4, v64, v65, v66
    v_max3_f32 v4, v4, v67, v68
    v_max3_f32 v4, v4, v69, v70
    v_max_f32 v4, v4, v71
    v_mul_f32 v4, s51, v4
    v_max3_f32 v5, v72, v73, v74
    v_max3_f32 v5, v5, v75, v76
    v_max3_f32 v5, v5, v77, v78
    v_max_f32 v5, v5, v79
    v_mul_f32 v5, s51, v5
    v_max3_f32 v26, v80, v81, v82
    v_max3_f32 v26, v26, v83, v84
    v_max3_f32 v26, v26, v85, v86
    v_max_f32 v26, v26, v87
    v_mul_f32 v26, s51, v26
    v_fma_f32 v48, v48, s51, -v4
    v_fma_f32 v49, v49, s51, -v4
    v_fma_f32 v50, v50, s51, -v4
    v_fma_f32 v51, v51, s51, -v4
    v_fma_f32 v52, v52, s51, -v4
    v_fma_f32 v53, v53, s51, -v4
    v_fma_f32 v54, v54, s51, -v4
    v_fma_f32 v55, v55, s51, -v4
    v_fma_f32 v56, v56, s51, -v5
    v_fma_f32 v57, v57, s51, -v5
    v_fma_f32 v58, v58, s51, -v5
    v_fma_f32 v59, v59, s51, -v5
    v_fma_f32 v60, v60, s51, -v5
    v_fma_f32 v61, v61, s51, -v5
    v_fma_f32 v62, v62, s51, -v5
    v_fma_f32 v63, v63, s51, -v5
    v_exp_f32 v48, v48
    v_exp_f32 v49, v49
    v_exp_f32 v50, v50
    v_exp_f32 v51, v51
    v_exp_f32 v52, v52
    v_exp_f32 v53, v53
    v_exp_f32 v54, v54
    v_exp_f32 v55, v55
    v_exp_f32 v56, v56
    v_exp_f32 v57, v57
    v_exp_f32 v58, v58
    v_exp_f32 v59, v59
    v_exp_f32 v60, v60
    v_exp_f32 v61, v61
    v_exp_f32 v62, v62
    v_exp_f32 v63, v63
    v_add_f32 v6, v48, v49
    v_add_f32 v6, v6, v50
    v_add_f32 v6, v6, v51
    v_add_f32 v6, v6, v52
    v_add_f32 v6, v6, v53
    v_add_f32 v6, v6, v54
    v_add_f32 v6, v6, v55
    v_add_f32 v7, v56, v57
    v_add_f32 v7, v7, v58
    v_add_f32 v7, v7, v59
    v_add_f32 v7, v7, v60
    v_add_f32 v7, v7, v61
    v_add_f32 v7, v7, v62
    v_add_f32 v7, v7, v63
    v_cvt_pk_bf16_f32 v48, v48, v49
    v_cvt_pk_bf16_f32 v49, v50, v51
    v_cvt_pk_bf16_f32 v50, v52, v53
    v_cvt_pk_bf16_f32 v51, v54, v55
    v_cvt_pk_bf16_f32 v52, v56, v57
    v_cvt_pk_bf16_f32 v53, v58, v59
    v_cvt_pk_bf16_f32 v54, v60, v61
    v_cvt_pk_bf16_f32 v55, v62, v63
    ds_write_b64 v38, v[48:49] offset:0
    ds_write_b64 v38, v[50:51] offset:256
    ds_write_b64 v38, v[52:53] offset:8192
    ds_write_b64 v38, v[54:55] offset:8448
    v_mov_b32 v8, v6
    v_mov_b32 v9, v7
    s_nop 0
    v_permlane16_swap_b32 v8, v6
    v_permlane16_swap_b32 v9, v7
    v_add_f32 v6, v6, v8
    v_add_f32 v7, v7, v9
    v_mov_b32 v8, v6
    v_mov_b32 v9, v7
    s_nop 0
    v_permlane32_swap_b32 v8, v6
    v_permlane32_swap_b32 v9, v7
    v_add_f32 v6, v6, v8
    v_add_f32 v7, v7, v9
    s_mov_b32 exec_lo, 0xffff
    s_mov_b32 exec_hi, 0x0
    ds_write_b32 v36, v6 offset:1024
    ds_write_b32 v36, v7 offset:1536
    s_mov_b64 exec, -1
    s_waitcnt lgkmcnt(0)
    s_barrier
    v_xor_b32 v21, 0, v20
    ds_read_b128 v[56:59], v21 offset:0
    ds_read_b64_tr_b16 v[48:49], v16 offset:0
    ds_read_b64_tr_b16 v[50:51], v17 offset:0
    ds_read_b64_tr_b16 v[52:53], v18 offset:0
    ds_read_b64_tr_b16 v[54:55], v19 offset:0
    v_xor_b32 v21, 32, v20
    ds_read_b128 v[68:71], v21 offset:0
    ds_read_b64_tr_b16 v[60:61], v16 offset:16384
    ds_read_b64_tr_b16 v[62:63], v17 offset:16384
    ds_read_b64_tr_b16 v[64:65], v18 offset:16384
    ds_read_b64_tr_b16 v[66:67], v19 offset:16384
    v_xor_b32 v21, 64, v20
    ds_read_b128 v[80:83], v21 offset:0
    ds_read_b64_tr_b16 v[72:73], v16 offset:32768
    ds_read_b64_tr_b16 v[74:75], v17 offset:32768
    ds_read_b64_tr_b16 v[76:77], v18 offset:32768
    ds_read_b64_tr_b16 v[78:79], v19 offset:32768
    s_waitcnt lgkmcnt(10)
    v_mfma_f32_32x32x16_bf16 v[96:111], v[48:51], v[56:59], 0
    v_mfma_f32_32x32x16_bf16 v[112:127], v[52:55], v[56:59], 0
    v_xor_b32 v21, 96, v20
    ds_read_b128 v[56:59], v21 offset:0
    ds_read_b64_tr_b16 v[48:49], v16 offset:49152
    ds_read_b64_tr_b16 v[50:51], v17 offset:49152
    ds_read_b64_tr_b16 v[52:53], v18 offset:49152
    ds_read_b64_tr_b16 v[54:55], v19 offset:49152
    s_waitcnt lgkmcnt(10)
    v_mfma_f32_32x32x16_bf16 v[96:111], v[60:63], v[68:71], v[96:111]
    v_mfma_f32_32x32x16_bf16 v[112:127], v[64:67], v[68:71], v[112:127]
    v_add_u32 v16, 0x10000, v16
    v_add_u32 v17, 0x10000, v17
    v_add_u32 v18, 0x10000, v18
    v_add_u32 v19, 0x10000, v19
    v_xor_b32 v21, 128, v20
    ds_read_b128 v[68:71], v21 offset:0
    ds_read_b64_tr_b16 v[60:61], v16 offset:0
    ds_read_b64_tr_b16 v[62:63], v17 offset:0
    ds_read_b64_tr_b16 v[64:65], v18 offset:0
    ds_read_b64_tr_b16 v[66:67], v19 offset:0
    s_waitcnt lgkmcnt(10)
    v_mfma_f32_32x32x16_bf16 v[96:111], v[72:75], v[80:83], v[96:111]
    v_mfma_f32_32x32x16_bf16 v[112:127], v[76:79], v[80:83], v[112:127]
    v_xor_b32 v21, 160, v20
    ds_read_b128 v[80:83], v21 offset:0
    ds_read_b64_tr_b16 v[72:73], v16 offset:16384
    ds_read_b64_tr_b16 v[74:75], v17 offset:16384
    ds_read_b64_tr_b16 v[76:77], v18 offset:16384
    ds_read_b64_tr_b16 v[78:79], v19 offset:16384
    s_waitcnt lgkmcnt(10)
    v_mfma_f32_32x32x16_bf16 v[96:111], v[48:51], v[56:59], v[96:111]
    v_mfma_f32_32x32x16_bf16 v[112:127], v[52:55], v[56:59], v[112:127]
    v_xor_b32 v21, 192, v20
    ds_read_b128 v[56:59], v21 offset:0
    ds_read_b64_tr_b16 v[48:49], v16 offset:32768
    ds_read_b64_tr_b16 v[50:51], v17 offset:32768
    ds_read_b64_tr_b16 v[52:53], v18 offset:32768
    ds_read_b64_tr_b16 v[54:55], v19 offset:32768
    s_waitcnt lgkmcnt(10)
    v_mfma_f32_32x32x16_bf16 v[96:111], v[60:63], v[68:71], v[96:111]
    v_mfma_f32_32x32x16_bf16 v[112:127], v[64:67], v[68:71], v[112:127]
    v_xor_b32 v21, 224, v20
    ds_read_b128 v[68:71], v21 offset:0
    ds_read_b64_tr_b16 v[60:61], v16 offset:49152
    ds_read_b64_tr_b16 v[62:63], v17 offset:49152
    ds_read_b64_tr_b16 v[64:65], v18 offset:49152
    ds_read_b64_tr_b16 v[66:67], v19 offset:49152
    s_waitcnt lgkmcnt(10)
    v_mfma_f32_32x32x16_bf16 v[96:111], v[72:75], v[80:83], v[96:111]
    v_mfma_f32_32x32x16_bf16 v[112:127], v[76:79], v[80:83], v[112:127]
    s_waitcnt lgkmcnt(5)
    v_mfma_f32_32x32x16_bf16 v[96:111], v[48:51], v[56:59], v[96:111]
    v_mfma_f32_32x32x16_bf16 v[112:127], v[52:55], v[56:59], v[112:127]
    s_waitcnt lgkmcnt(0)
    v_mfma_f32_32x32x16_bf16 v[96:111], v[60:63], v[68:71], v[96:111]
    v_mfma_f32_32x32x16_bf16 v[112:127], v[64:67], v[68:71], v[112:127]
    v_subrev_u32 v16, 0x10000, v16
    v_subrev_u32 v17, 0x10000, v17
    v_subrev_u32 v18, 0x10000, v18
    v_subrev_u32 v19, 0x10000, v19
    s_waitcnt lgkmcnt(0)
    s_barrier
    s_and_b32 s62, s53, 7
    s_lshl_b32 s62, s62, 14
    s_lshr_b32 s63, s3, 1
    s_lshl_b32 s63, s63, 12
    s_add_u32 s62, s62, s63
    s_lshr_b32 s63, s53, 3
    s_lshl_b32 s63, s63, 9
    s_add_u32 s62, s62, s63
    s_and_b32 s63, s3, 1
    s_lshl_b32 s63, s63, 8
    s_add_u32 s62, s62, s63
    s_add_u32 s42, s30, s62
    s_addc_u32 s43, s31, 0
    s_add_u32 s42, s42, 196608
    s_addc_u32 s43, s43, 0
    s_cmp_ge_u32 s3, 6
    s_cbranch_scc0 L_skip_75
    s_and_b32 s62, s53, 7
    s_lshl_b32 s62, s62, 7
    s_add_u32 s60, s30, s62
    s_addc_u32 s61, s31, 0
    s_add_u32 s60, s60, 638976
    s_addc_u32 s61, s61, 0
    v_and_b32 v32, 31, v0
    v_lshlrev_b32 v32, 2, v32
    global_load_dword v32, v32, s[60:61] sc1
L_skip_75:
    global_load_dwordx4 v[22:25], v30, s[42:43] offset:0 sc1
    ds_write_b128 v40, v[184:187] offset:0
    ds_write_b128 v41, v[196:199] offset:0
    ds_write_b128 v42, v[192:195] offset:0
    ds_write_b128 v43, v[204:207] offset:0
    ds_write_b128 v40, v[200:203] offset:256
    ds_write_b128 v41, v[212:215] offset:256
    ds_write_b128 v42, v[208:211] offset:256
    ds_write_b128 v43, v[220:223] offset:256
    ds_write_b128 v40, v[216:219] offset:512
    ds_write_b128 v41, v[228:231] offset:512
    ds_write_b128 v42, v[224:227] offset:512
    ds_write_b128 v43, v[236:239] offset:512
    ds_write_b128 v40, v[232:235] offset:768
    ds_write_b128 v41, v[244:247] offset:768
    ds_write_b128 v42, v[240:243] offset:768
    ds_write_b128 v43, v[252:255] offset:768
    global_load_dwordx4 v[160:163], v29, s[46:47] offset:0 nt
    global_load_dwordx4 v[164:167], v29, s[46:47] offset:1024 nt
    global_load_dwordx4 v[168:171], v29, s[46:47] offset:2048 nt
    global_load_dwordx4 v[172:175], v29, s[46:47] offset:3072 nt
    s_add_u32 s46, s46, 4096
    s_addc_u32 s47, s47, 0
    s_waitcnt lgkmcnt(0)
    s_barrier
    v_xor_b32 v21, 0, v20
    ds_read_b128 v[56:59], v21 offset:256
    ds_read_b64_tr_b16 v[48:49], v16 offset:0
    ds_read_b64_tr_b16 v[50:51], v17 offset:0
    ds_read_b64_tr_b16 v[52:53], v18 offset:0
    ds_read_b64_tr_b16 v[54:55], v19 offset:0
    v_xor_b32 v21, 32, v20
    ds_read_b128 v[68:71], v21 offset:256
    ds_read_b64_tr_b16 v[60:61], v16 offset:16384
    ds_read_b64_tr_b16 v[62:63], v17 offset:16384
    ds_read_b64_tr_b16 v[64:65], v18 offset:16384
    ds_read_b64_tr_b16 v[66:67], v19 offset:16384
    v_xor_b32 v21, 64, v20
    ds_read_b128 v[80:83], v21 offset:256
    ds_read_b64_tr_b16 v[72:73], v16 offset:32768
    ds_read_b64_tr_b16 v[74:75], v17 offset:32768
    ds_read_b64_tr_b16 v[76:77], v18 offset:32768
    ds_read_b64_tr_b16 v[78:79], v19 offset:32768
    s_waitcnt lgkmcnt(10)
    v_mfma_f32_32x32x16_bf16 v[96:111], v[48:51], v[56:59], v[96:111]
    v_mfma_f32_32x32x16_bf16 v[112:127], v[52:55], v[56:59], v[112:127]
    v_xor_b32 v21, 96, v20
    ds_read_b128 v[56:59], v21 offset:256
    ds_read_b64_tr_b16 v[48:49], v16 offset:49152
    ds_read_b64_tr_b16 v[50:51], v17 offset:49152
    ds_read_b64_tr_b16 v[52:53], v18 offset:49152
    ds_read_b64_tr_b16 v[54:55], v19 offset:49152
    s_waitcnt lgkmcnt(10)
    v_mfma_f32_32x32x16_bf16 v[96:111], v[60:63], v[68:71], v[96:111]
    v_mfma_f32_32x32x16_bf16 v[112:127], v[64:67], v[68:71], v[112:127]
    v_add_u32 v16, 0x10000, v16
    v_add_u32 v17, 0x10000, v17
    v_add_u32 v18, 0x10000, v18
    v_add_u32 v19, 0x10000, v19
    v_xor_b32 v21, 128, v20
    ds_read_b128 v[68:71], v21 offset:256
    ds_read_b64_tr_b16 v[60:61], v16 offset:0
    ds_read_b64_tr_b16 v[62:63], v17 offset:0
    ds_read_b64_tr_b16 v[64:65], v18 offset:0
    ds_read_b64_tr_b16 v[66:67], v19 offset:0
    s_waitcnt lgkmcnt(10)
    v_mfma_f32_32x32x16_bf16 v[96:111], v[72:75], v[80:83], v[96:111]
    v_mfma_f32_32x32x16_bf16 v[112:127], v[76:79], v[80:83], v[112:127]
    v_xor_b32 v21, 160, v20
    ds_read_b128 v[80:83], v21 offset:256
    ds_read_b64_tr_b16 v[72:73], v16 offset:16384
    ds_read_b64_tr_b16 v[74:75], v17 offset:16384
    ds_read_b64_tr_b16 v[76:77], v18 offset:16384
    ds_read_b64_tr_b16 v[78:79], v19 offset:16384
    s_waitcnt lgkmcnt(10)
    v_mfma_f32_32x32x16_bf16 v[96:111], v[48:51], v[56:59], v[96:111]
    v_mfma_f32_32x32x16_bf16 v[112:127], v[52:55], v[56:59], v[112:127]
    v_xor_b32 v21, 192, v20
    ds_read_b128 v[56:59], v21 offset:256
    ds_read_b64_tr_b16 v[48:49], v16 offset:32768
    ds_read_b64_tr_b16 v[50:51], v17 offset:32768
    ds_read_b64_tr_b16 v[52:53], v18 offset:32768
    ds_read_b64_tr_b16 v[54:55], v19 offset:32768
    s_waitcnt lgkmcnt(10)
    v_mfma_f32_32x32x16_bf16 v[96:111], v[60:63], v[68:71], v[96:111]
    v_mfma_f32_32x32x16_bf16 v[112:127], v[64:67], v[68:71], v[112:127]
    v_xor_b32 v21, 224, v20
    ds_read_b128 v[68:71], v21 offset:256
    ds_read_b64_tr_b16 v[60:61], v16 offset:49152
    ds_read_b64_tr_b16 v[62:63], v17 offset:49152
    ds_read_b64_tr_b16 v[64:65], v18 offset:49152
    ds_read_b64_tr_b16 v[66:67], v19 offset:49152
    s_waitcnt lgkmcnt(10)
    v_mfma_f32_32x32x16_bf16 v[96:111], v[72:75], v[80:83], v[96:111]
    v_mfma_f32_32x32x16_bf16 v[112:127], v[76:79], v[80:83], v[112:127]
    s_waitcnt lgkmcnt(5)
    v_mfma_f32_32x32x16_bf16 v[96:111], v[48:51], v[56:59], v[96:111]
    v_mfma_f32_32x32x16_bf16 v[112:127], v[52:55], v[56:59], v[112:127]
    s_waitcnt lgkmcnt(0)
    v_mfma_f32_32x32x16_bf16 v[96:111], v[60:63], v[68:71], v[96:111]
    v_mfma_f32_32x32x16_bf16 v[112:127], v[64:67], v[68:71], v[112:127]
    ds_read_b128 v[64:67], v37 offset:1024
    ds_read_b128 v[68:71], v37 offset:1040
    v_mov_b32 v12, 0
    v_mov_b32 v13, 0
    v_mov_b32 v14, 0
    v_mov_b32 v15, 0
    v_mov_b32 v11, 9728
    s_waitcnt lgkmcnt(0)
    v_add_f32 v9, v64, v65
    v_add_f32 v9, v9, v66
    v_add_f32 v9, v9, v67
    v_add_f32 v9, v9, v68
    v_add_f32 v9, v9, v69
    v_add_f32 v9, v9, v70
    v_add_f32 v9, v9, v71
    v_rcp_f32 v10, v9
    v_log_f32 v9, v9
    s_nop 0
    v_add_f32 v26, v26, v9
    s_barrier
    ds_write_b128 v11, v[12:15]
    v_mul_f32 v96, v10, v96
    v_mul_f32 v97, v10, v97
    v_mul_f32 v98, v10, v98
    v_mul_f32 v99, v10, v99
    v_cvt_pk_bf16_f32 v96, v96, v97
    v_cvt_pk_bf16_f32 v97, v98, v99
    v_xor_b32 v40, 0, v39
    ds_write_b64 v40, v[96:97]
    v_mul_f32 v100, v10, v100
    v_mul_f32 v101, v10, v101
    v_mul_f32 v102, v10, v102
    v_mul_f32 v103, v10, v103
    v_cvt_pk_bf16_f32 v100, v100, v101
    v_cvt_pk_bf16_f32 v101, v102, v103
    v_xor_b32 v41, 16, v39
    ds_write_b64 v41, v[100:101]
    v_mul_f32 v104, v10, v104
    v_mul_f32 v105, v10, v105
    v_mul_f32 v106, v10, v106
    v_mul_f32 v107, v10, v107
    v_cvt_pk_bf16_f32 v104, v104, v105
    v_cvt_pk_bf16_f32 v105, v106, v107
    v_xor_b32 v42, 32, v39
    ds_write_b64 v42, v[104:105]
    v_mul_f32 v108, v10, v108
    v_mul_f32 v109, v10, v109
    v_mul_f32 v110, v10, v110
    v_mul_f32 v111, v10, v111
    v_cvt_pk_bf16_f32 v108, v108, v109
    v_cvt_pk_bf16_f32 v109, v110, v111
    v_xor_b32 v43, 48, v39
    ds_write_b64 v43, v[108:109]
    v_mul_f32 v112, v10, v112
    v_mul_f32 v113, v10, v113
    v_mul_f32 v114, v10, v114
    v_mul_f32 v115, v10, v115
    v_cvt_pk_bf16_f32 v112, v112, v113
    v_cvt_pk_bf16_f32 v113, v114, v115
    v_xor_b32 v44, 64, v39
    ds_write_b64 v44, v[112:113]
    v_mul_f32 v116, v10, v116
    v_mul_f32 v117, v10, v117
    v_mul_f32 v118, v10, v118
    v_mul_f32 v119, v10, v119
    v_cvt_pk_bf16_f32 v116, v116, v117
    v_cvt_pk_bf16_f32 v117, v118, v119
    v_xor_b32 v45, 80, v39
    ds_write_b64 v45, v[116:117]
    v_mul_f32 v120, v10, v120
    v_mul_f32 v121, v10, v121
    v_mul_f32 v122, v10, v122
    v_mul_f32 v123, v10, v123
    v_cvt_pk_bf16_f32 v120, v120, v121
    v_cvt_pk_bf16_f32 v121, v122, v123
    v_xor_b32 v46, 96, v39
    ds_write_b64 v46, v[120:121]
    v_mul_f32 v124, v10, v124
    v_mul_f32 v125, v10, v125
    v_mul_f32 v126, v10, v126
    v_mul_f32 v127, v10, v127
    v_cvt_pk_bf16_f32 v124, v124, v125
    v_cvt_pk_bf16_f32 v125, v126, v127
    v_xor_b32 v47, 112, v39
    ds_write_b64 v47, v[124:125]
    s_waitcnt lgkmcnt(0)
    s_barrier
    v_xor_b32 v16, 0, v27
    ds_read_b128 v[192:195], v16 offset:0
    v_xor_b32 v17, 16, v27
    ds_read_b128 v[196:199], v17 offset:1024
    v_xor_b32 v18, 32, v27
    ds_read_b128 v[200:203], v18 offset:2048
    v_xor_b32 v19, 48, v27
    ds_read_b128 v[204:207], v19 offset:3072
    s_waitcnt lgkmcnt(3)
    global_store_dwordx4 v33, v[192:195], s[94:95] sc1
    s_add_u32 s94, s94, 65536
    s_addc_u32 s95, s95, 0
    s_waitcnt lgkmcnt(2)
    global_store_dwordx4 v33, v[196:199], s[94:95] sc1
    s_add_u32 s94, s94, 65536
    s_addc_u32 s95, s95, 0
    s_waitcnt lgkmcnt(1)
    global_store_dwordx4 v33, v[200:203], s[94:95] sc1
    s_add_u32 s94, s94, 65536
    s_addc_u32 s95, s95, 0
    s_waitcnt lgkmcnt(0)
    global_store_dwordx4 v33, v[204:207], s[94:95] sc1
    s_mov_b32 s52, 2097152
    s_waitcnt vmcnt(8)
    v_perm_b32 v5, v25, v22, s48
    v_cmp_ne_u32 s[60:61], s49, v5
    s_nop 0
    s_cmp_eq_u64 s[60:61], 0
    s_cbranch_scc1 L_got_77
L_poll_76:
    s_sub_u32 s52, s52, 1
    s_cbranch_scc1 L_got_77
    global_load_dwordx4 v[22:25], v30, s[42:43] offset:0 sc1
    s_waitcnt vmcnt(0)
    v_perm_b32 v5, v25, v22, s48
    v_cmp_ne_u32 s[60:61], s49, v5
    s_nop 0
    s_cmp_eq_u64 s[60:61], 0
    s_cbranch_scc0 L_poll_76
L_got_77:
    s_cmp_ge_u32 s3, 6
    s_cbranch_scc0 L_skip_78
    v_cmp_ne_u32 s[60:61], s33, v32
    s_nop 0
    s_cmp_eq_u64 s[60:61], 0
    s_cselect_b32 s90, 1, 0
L_skip_78:
    v_and_b32 v22, s50, v22
    v_and_b32 v23, s50, v23
    v_and_b32 v24, s50, v24
    v_and_b32 v25, s50, v25
    v_mov_b32 v80, v22
    v_mov_b32 v81, v23
    v_mov_b32 v82, v24
    v_mov_b32 v83, v25
    v_permlane16_swap_b32 v80, v22
    v_permlane16_swap_b32 v81, v23
    v_permlane16_swap_b32 v82, v24
    v_permlane16_swap_b32 v83, v25
    v_add_f32 v22, v22, v80
    v_add_f32 v23, v23, v81
    v_add_f32 v24, v24, v82
    v_add_f32 v25, v25, v83
    v_mov_b32 v80, v22
    v_mov_b32 v81, v23
    v_mov_b32 v82, v24
    v_mov_b32 v83, v25
    v_permlane32_swap_b32 v80, v22
    v_permlane32_swap_b32 v81, v23
    v_permlane32_swap_b32 v82, v24
    v_permlane32_swap_b32 v83, v25
    v_add_f32 v22, v22, v80
    v_add_f32 v23, v23, v81
    v_add_f32 v24, v24, v82
    v_add_f32 v25, v25, v83
    v_cvt_pk_bf16_f32 v22, v22, v23
    v_cvt_pk_bf16_f32 v23, v24, v25
    s_lshl_b32 s62, s3, 7
    v_lshlrev_b32 v4, 3, v1
    v_add_u32 v4, s62, v4
    s_mov_b32 exec_lo, 0xffff
    s_mov_b32 exec_hi, 0x0
    ds_write_b64 v4, v[22:23] offset:8192
    v_mov_b32 v6, 1
    v_mov_b32 v7, 9728
    s_mov_b32 exec_lo, 0x1
    s_mov_b32 exec_hi, 0x0
    ds_add_u32 v7, v6
    s_mov_b64 exec, -1
    v_mov_b32 v7, 9728
    s_mov_b32 s52, 33554432
L_cnt_79:
    ds_read_b32 v6, v7
    s_sub_u32 s52, s52, 1
    s_cbranch_scc1 L_cntok_80
    s_waitcnt lgkmcnt(0)
    v_readfirstlane_b32 s62, v6
    s_nop 0
    s_cmp_lt_u32 s62, 8
    s_cbranch_scc1 L_cnt_79
L_cntok_80:
    v_lshrrev_b32 v4, 2, v1
    v_lshlrev_b32 v4, 8, v4
    v_lshl_add_u32 v4, v2, 5, v4
    ds_read_b128 v[64:67], v4 offset:8192
    ds_read_b128 v[68:71], v4 offset:8208
    ds_read_b128 v[72:75], v4 offset:8320
    ds_read_b128 v[76:79], v4 offset:8336
    v_lshlrev_b32 v40, 3, v0
    v_mov_b32 v27, v3
    s_waitcnt lgkmcnt(0)
    s_waitcnt vmcnt(9)
    s_mov_b64 vcc, s[96:97]
    v_cndmask_b32_dpp v80, v132, v128, vcc quad_perm:[1,0,3,2] row_mask:0xf bank_mask:0xf
    v_xor_b32 v128, v128, v80
    v_cndmask_b32_dpp v81, v133, v129, vcc quad_perm:[1,0,3,2] row_mask:0xf bank_mask:0xf
    v_xor_b32 v129, v129, v81
    v_cndmask_b32_dpp v82, v134, v130, vcc quad_perm:[1,0,3,2] row_mask:0xf bank_mask:0xf
    v_xor_b32 v130, v130, v82
    v_cndmask_b32_dpp v83, v135, v131, vcc quad_perm:[1,0,3,2] row_mask:0xf bank_mask:0xf
    v_xor_b32 v131, v131, v83
    v_xor_b32_dpp v132, v128, v132 quad_perm:[1,0,3,2] row_mask:0xf bank_mask:0xf
    v_xor_b32_dpp v133, v129, v133 quad_perm:[1,0,3,2] row_mask:0xf bank_mask:0xf
    v_xor_b32_dpp v134, v130, v134 quad_perm:[1,0,3,2] row_mask:0xf bank_mask:0xf
    v_xor_b32_dpp v135, v131, v135 quad_perm:[1,0,3,2] row_mask:0xf bank_mask:0xf
    v_cndmask_b32_dpp v84, v140, v136, vcc quad_perm:[1,0,3,2] row_mask:0xf bank_mask:0xf
    v_xor_b32 v136, v136, v84
    v_cndmask_b32_dpp v85, v141, v137, vcc quad_perm:[1,0,3,2] row_mask:0xf bank_mask:0xf
    v_xor_b32 v137, v137, v85
    v_cndmask_b32_dpp v86, v142, v138, vcc quad_perm:[1,0,3,2] row_mask:0xf bank_mask:0xf
    v_xor_b32 v138, v138, v86
    v_cndmask_b32_dpp v87, v143, v139, vcc quad_perm:[1,0,3,2] row_mask:0xf bank_mask:0xf
    v_xor_b32 v139, v139, v87
    v_xor_b32_dpp v140, v136, v140 quad_perm:[1,0,3,2] row_mask:0xf bank_mask:0xf
    v_xor_b32_dpp v141, v137, v141 quad_perm:[1,0,3,2] row_mask:0xf bank_mask:0xf
    v_xor_b32_dpp v142, v138, v142 quad_perm:[1,0,3,2] row_mask:0xf bank_mask:0xf
    v_xor_b32_dpp v143, v139, v143 quad_perm:[1,0,3,2] row_mask:0xf bank_mask:0xf
    v_mfma_f32_16x16x32_bf16 v[48:51], v[80:83], v[64:67], 0
    v_mfma_f32_16x16x32_bf16 v[48:51], v[132:135], v[68:71], v[48:51]
    v_mfma_f32_16x16x32_bf16 v[48:51], v[84:87], v[72:75], v[48:51]
    v_mfma_f32_16x16x32_bf16 v[48:51], v[140:143], v[76:79], v[48:51]
    s_nop 7
    v_max3_f32 v4, v48, v49, v50
    v_max_f32 v4, v4, v51
    v_mov_b32 v5, v4
    s_nop 1
    v_permlane16_swap_b32 v5, v4
    v_max_f32 v4, v4, v5
    v_mov_b32 v5, v4
    s_nop 1
    v_permlane32_swap_b32 v5, v4
    v_max_f32 v4, v4, v5
    v_mul_f32 v4, s51, v4
    v_fma_f32 v48, v48, s51, -v4
    v_fma_f32 v49, v49, s51, -v4
    v_fma_f32 v50, v50, s51, -v4
    v_fma_f32 v51, v51, s51, -v4
    v_exp_f32 v48, v48
    v_exp_f32 v49, v49
    v_exp_f32 v50, v50
    v_exp_f32 v51, v51
    v_add_f32 v5, v48, v49
    v_add_f32 v5, v5, v50
    v_add_f32 v5, v5, v51
    v_cvt_pk_bf16_f32 v48, v48, v49
    v_cvt_pk_bf16_f32 v49, v50, v51
    v_mov_b32 v6, v5
    s_nop 1
    v_permlane16_swap_b32 v6, v5
    v_add_f32 v5, v5, v6
    v_mov_b32 v6, v5
    s_nop 1
    v_permlane32_swap_b32 v6, v5
    v_add_f32 v5, v5, v6
    s_lshl_b32 s62, s3, 5
    v_lshlrev_b32 v6, 1, v1
    v_add_u32 v6, s62, v6
    s_mov_b32 exec_lo, 0x1111
    s_mov_b32 exec_hi, 0x0
    ds_write_b64 v6, v[4:5] offset:9216
    v_mov_b32 v6, 1
    v_mov_b32 v7, 9732
    s_mov_b32 exec_lo, 0x1
    s_mov_b32 exec_hi, 0x0
    ds_add_u32 v7, v6
    s_mov_b64 exec, -1
    s_waitcnt vmcnt(0)
    s_barrier
    s_cmp_eq_u32 s3, 7
    s_cbranch_scc0 L_skip_81
    s_mov_b32 exec_lo, 0xffffffff
    s_mov_b32 exec_hi, 0x0
    global_store_dwordx2 v40, v[26:27], s[100:101] sc1
    s_mov_b64 exec, -1
L_skip_81:
    v_mov_b32 v7, 9732
    s_mov_b32 s52, 33554432
L_cnt_82:
    ds_read_b32 v6, v7
    s_sub_u32 s52, s52, 1
    s_cbranch_scc1 L_cntok_83
    s_waitcnt lgkmcnt(0)
    v_readfirstlane_b32 s62, v6
    s_nop 0
    s_cmp_lt_u32 s62, 8
    s_cbranch_scc1 L_cnt_82
L_cntok_83:
    v_lshlrev_b32 v6, 3, v2
    ds_read_b64 v[208:209], v6 offset:9216
    ds_read_b64 v[210:211], v6 offset:9248
    ds_read_b64 v[212:213], v6 offset:9280
    ds_read_b64 v[214:215], v6 offset:9312
    ds_read_b64 v[216:217], v6 offset:9344
    ds_read_b64 v[218:219], v6 offset:9376
    ds_read_b64 v[220:221], v6 offset:9408
    ds_read_b64 v[222:223], v6 offset:9440
    s_lshl_b32 s62, s3, 5
    v_add_u32 v6, s62, v6
    ds_read_b64 v[4:5], v6 offset:9216
    s_waitcnt lgkmcnt(0)
    v_max3_f32 v7, v208, v210, v212
    v_max3_f32 v7, v7, v214, v216
    v_max3_f32 v7, v7, v218, v220
    v_max_f32 v7, v7, v222
    v_sub_f32 v208, v208, v7
    v_sub_f32 v210, v210, v7
    v_sub_f32 v212, v212, v7
    v_sub_f32 v214, v214, v7
    v_sub_f32 v216, v216, v7
    v_sub_f32 v218, v218, v7
    v_sub_f32 v220, v220, v7
    v_sub_f32 v222, v222, v7
    v_sub_f32 v4, v4, v7
    v_exp_f32 v208, v208
    v_exp_f32 v210, v210
    v_exp_f32 v212, v212
    v_exp_f32 v214, v214
    v_exp_f32 v216, v216
    v_exp_f32 v218, v218
    v_exp_f32 v220, v220
    v_exp_f32 v222, v222
    v_exp_f32 v4, v4
    v_mul_f32 v5, v208, v209
    v_fmac_f32 v5, v210, v211
    v_fmac_f32 v5, v212, v213
    v_fmac_f32 v5, v214, v215
    v_fmac_f32 v5, v216, v217
    v_fmac_f32 v5, v218, v219
    v_fmac_f32 v5, v220, v221
    v_fmac_f32 v5, v222, v223
    v_rcp_f32 v6, v5
    v_log_f32 v5, v5
    v_mul_f32 v31, v4, v6
    s_cmp_eq_u32 s3, 7
    s_cbranch_scc0 L_skip_84
    v_add_f32 v8, v5, v7
    v_add_f32 v9, v5, v7
    v_add_f32 v10, v5, v7
    v_add_f32 v11, v5, v7
    v_perm_b32 v8, v8, v3, s34
    v_perm_b32 v9, v9, v3, s35
    v_perm_b32 v10, v10, v3, s36
    v_perm_b32 v11, v11, v3, s37
    s_and_b32 s62, s53, 7
    s_lshl_b32 s62, s62, 11
    s_lshr_b32 s63, s53, 3
    s_lshl_b32 s63, s63, 8
    s_add_u32 s62, s62, s63
    s_lshl_b32 s63, s54, 4
    s_add_u32 s62, s62, s63
    s_add_u32 s42, s30, s62
    s_addc_u32 s43, s31, 0
    s_add_u32 s42, s42, 655360
    s_addc_u32 s43, s43, 0
    v_lshlrev_b32 v4, 9, v2
    s_mov_b32 exec_lo, 0x10001
    s_mov_b32 exec_hi, 0x10001
    s_cmp_lg_u32 s90, 0
    s_cbranch_scc1 L_sl_85
    global_store_dwordx4 v4, v[8:11], s[42:43] sc1
    s_branch L_sd_86
L_sl_85:
    global_store_dwordx4 v4, v[8:11], s[42:43]
L_sd_86:
    s_mov_b64 exec, -1
L_skip_84:
    s_and_b32 s62, s53, 7
    s_lshl_b32 s62, s62, 3
    s_and_b32 s63, s3, 1
    s_lshl_b32 s63, s63, 2
    s_add_u32 s62, s62, s63
    s_lshr_b32 s63, s53, 3
    s_add_u32 s62, s62, s63
    s_mul_i32 s62, s62, 16
    s_add_u32 s62, s62, s54
    s_lshl_b32 s62, s62, 9
    s_add_u32 s42, s30, s62
    s_addc_u32 s43, s31, 0
    s_add_u32 s42, s42, 720896
    s_addc_u32 s43, s43, 0
    v_lshrrev_b32 v4, 5, v0
    v_mul_u32_u24 v4, 16384, v4
    v_and_b32 v5, 31, v0
    v_lshl_add_u32 v30, v5, 4, v4
    s_lshl_b32 s62, s3, 11
    v_lshlrev_b32 v4, 9, v2
    v_lshl_add_u32 v4, v1, 5, v4
    v_add_u32 v28, s62, v4
    s_and_b32 s62, s3, 1
    s_lshl_b32 s62, s62, 10
    v_add_u32 v208, s62, v29
    s_waitcnt vmcnt(4)
    v_perm_b32 v80, v164, v160, s38
    v_perm_b32 v81, v172, v168, s38
    s_nop 1
    v_mfma_f32_16x16x16_bf16 v[96:99], v[48:49], v[80:81], 0
    v_perm_b32 v84, v164, v160, s39
    v_perm_b32 v85, v172, v168, s39
    s_nop 1
    v_mfma_f32_16x16x16_bf16 v[100:103], v[48:49], v[84:85], 0
    v_perm_b32 v88, v165, v161, s38
    v_perm_b32 v89, v173, v169, s38
    s_nop 1
    v_mfma_f32_16x16x16_bf16 v[104:107], v[48:49], v[88:89], 0
    v_perm_b32 v92, v165, v161, s39
    v_perm_b32 v93, v173, v169, s39
    s_nop 1
    v_mfma_f32_16x16x16_bf16 v[108:111], v[48:49], v[92:93], 0
    v_perm_b32 v80, v166, v162, s38
    v_perm_b32 v81, v174, v170, s38
    s_nop 1
    v_mfma_f32_16x16x16_bf16 v[112:115], v[48:49], v[80:81], 0
    v_perm_b32 v84, v166, v162, s39
    v_perm_b32 v85, v174, v170, s39
    s_nop 1
    v_mfma_f32_16x16x16_bf16 v[116:119], v[48:49], v[84:85], 0
    v_perm_b32 v88, v167, v163, s38
    v_perm_b32 v89, v175, v171, s38
    s_nop 1
    v_mfma_f32_16x16x16_bf16 v[120:123], v[48:49], v[88:89], 0
    v_perm_b32 v92, v167, v163, s39
    v_perm_b32 v93, v175, v171, s39
    s_nop 1
    v_mfma_f32_16x16x16_bf16 v[124:127], v[48:49], v[92:93], 0
    v_mul_f32 v212, v31, v96
    v_mul_f32 v213, v31, v100
    v_mul_f32 v214, v31, v104
    v_mul_f32 v215, v31, v108
    v_mul_f32 v216, v31, v112
    v_mul_f32 v217, v31, v116
    v_mul_f32 v218, v31, v120
    s_nop 0
    v_mul_f32 v219, v31, v124
    ds_write_b128 v28, v[212:215] offset:10240
    ds_write_b128 v28, v[216:219] offset:10256
    s_waitcnt lgkmcnt(0)
    s_barrier
    s_cmp_ge_u32 s3, 6
    s_cbranch_scc0 L_skip_87
    ds_read_b128 v[212:215], v208 offset:10240
    ds_read_b128 v[216:219], v208 offset:12288
    ds_read_b128 v[220:223], v208 offset:14336
    ds_read_b128 v[224:227], v208 offset:16384
    ds_read_b128 v[228:231], v208 offset:18432
    ds_read_b128 v[232:235], v208 offset:20480
    ds_read_b128 v[236:239], v208 offset:22528
    ds_read_b128 v[240:243], v208 offset:24576
    s_waitcnt lgkmcnt(0)
    v_add_f32 v212, v212, v228
    v_add_f32 v213, v213, v229
    v_add_f32 v214, v214, v230
    v_add_f32 v215, v215, v231
    v_add_f32 v216, v216, v232
    v_add_f32 v217, v217, v233
    v_add_f32 v218, v218, v234
    v_add_f32 v219, v219, v235
    v_add_f32 v220, v220, v236
    v_add_f32 v221, v221, v237
    v_add_f32 v222, v222, v238
    v_add_f32 v223, v223, v239
    v_add_f32 v224, v224, v240
    v_add_f32 v225, v225, v241
    v_add_f32 v226, v226, v242
    v_add_f32 v227, v227, v243
    v_add_f32 v212, v212, v220
    v_add_f32 v213, v213, v221
    v_add_f32 v214, v214, v222
    v_add_f32 v215, v215, v223
    v_add_f32 v216, v216, v224
    v_add_f32 v217, v217, v225
    v_add_f32 v218, v218, v226
    v_add_f32 v219, v219, v227
    v_add_f32 v212, v212, v216
    v_add_f32 v213, v213, v217
    v_add_f32 v214, v214, v218
    v_add_f32 v215, v215, v219
    v_perm_b32 v212, v212, v3, s34
    v_perm_b32 v213, v213, v3, s35
    v_perm_b32 v214, v214, v3, s36
    v_perm_b32 v215, v215, v3, s37
    s_cmp_lg_u32 s90, 0
    s_cbranch_scc1 L_sl_88
    global_store_dwordx4 v30, v[212:215], s[42:43] sc1
    s_branch L_sd_89
L_sl_88:
    global_store_dwordx4 v30, v[212:215], s[42:43]
L_sd_89:
L_skip_87:
    s_branch L_fin
L_roleB:
    s_sub_u32 s57, s2, 96
    s_getpc_b64 s[44:45]
L_pc:
    s_lshl_b32 s62, s57, 2
    s_add_u32 s44, s44, L_tiles-L_pc
    s_addc_u32 s45, s45, 0
    s_load_dword s55, s[44:45], s62
    s_cmp_ge_u32 s2, 224
    s_cbranch_scc1 L_roleB2
    s_and_b32 s62, s57, 7
    s_lshl_b32 s62, s62, 4
    s_lshr_b32 s63, s57, 3
    s_add_u32 s62, s62, s63
    s_mov_b32 s57, s62
    s_bitcmp1_b32 s57, 3
    s_cselect_b32 s100, 120, 8
    s_add_u32 s100, s100, s57
    v_lshlrev_b32 v4, 15, v2
    v_lshl_add_u32 v4, v1, 4, v4
    v_bfe_u32 v5, v1, 2, 1
    v_lshlrev_b32 v5, 10, v5
    v_lshl_add_u32 v5, v2, 3, v5
    s_and_b32 s62, s100, 3
    s_lshl_b32 s62, s62, 7
    s_lshl_b32 s63, s3, 4
    s_add_u32 s62, s62, s63
    s_lshl_b32 s40, s62, 13
    s_lshr_b32 s63, s100, 2
    s_and_b32 s63, s63, 31
    s_lshl_b32 s63, s63, 8
    s_add_u32 s40, s40, s63
    s_lshl_b32 s62, s62, 1
    s_waitcnt lgkmcnt(0)
    s_cmp_lt_u32 s100, 128
    s_cselect_b32 s44, s8, s22
    s_cselect_b32 s45, s9, s23
    s_cselect_b32 s42, s4, s16
    s_cselect_b32 s43, s5, s17
    s_add_u32 s40, s44, s40
    s_addc_u32 s41, s45, 0
    s_add_u32 s42, s42, s62
    s_addc_u32 s43, s43, 0
    global_load_dwordx2 v[8:9], v5, s[42:43]
    global_load_dwordx4 v[16:19], v4, s[40:41] offset:0 nt
    s_add_u32 s40, s40, 8192
    s_addc_u32 s41, s41, 0
    global_load_dwordx4 v[20:23], v4, s[40:41] offset:0 nt
    s_add_u32 s40, s40, 8192
    s_addc_u32 s41, s41, 0
    global_load_dwordx4 v[24:27], v4, s[40:41] offset:0 nt
    s_add_u32 s40, s40, 8192
    s_addc_u32 s41, s41, 0
    global_load_dwordx4 v[28:31], v4, s[40:41] offset:0 nt
    s_barrier
    s_and_b32 s62, s57, 3
    s_lshl_b32 s62, s62, 20
    s_lshl_b32 s63, s3, 17
    s_add_u32 s62, s62, s63
    s_lshr_b32 s63, s57, 2
    s_lshl_b32 s63, s63, 8
    s_add_u32 s62, s62, s63
    s_add_u32 s44, s10, s62
    s_addc_u32 s45, s11, 0
    v_bfe_u32 v33, v0, 1, 3
    v_lshlrev_b32 v33, 14, v33
    v_lshl_add_u32 v33, v2, 5, v33
    v_and_b32 v32, 1, v0
    v_lshl_add_u32 v33, v32, 4, v33
    v_add_u32 v32, 0x2000, v33
    global_load_dwordx4 v[144:147], v33, s[44:45] offset:0 nt
    global_load_dwordx4 v[152:155], v33, s[44:45] offset:128 nt
    global_load_dwordx4 v[148:151], v32, s[44:45] offset:0 nt
    global_load_dwordx4 v[156:159], v32, s[44:45] offset:128 nt
    s_load_dword s32, s[30:31], 0
    s_mov_b32 s34, 0x7060500
    s_mov_b32 s35, 0x7060501
    s_mov_b32 s36, 0x7060502
    s_mov_b32 s37, 0x7060503
    s_mov_b32 s38, 0x05040100
    s_mov_b32 s39, 0x07060302
    s_mov_b32 s48, 0x0c0c0400
    s_mov_b32 s51, 0x3e0293ee
    s_mov_b32 s96, 0x55555555
    s_mov_b32 s97, 0x55555555
    s_cmp_eq_u32 s3, 1
    s_cbranch_scc0 L_skip_90
    s_and_b32 s62, s2, 7
    s_lshl_b32 s62, s62, 7
    s_lshr_b32 s63, s2, 3
    s_lshl_b32 s63, s63, 2
    s_add_u32 s62, s62, s63
    s_add_u32 s60, s30, s62
    s_addc_u32 s61, s31, 0
    s_add_u32 s60, s60, 638976
    s_addc_u32 s61, s61, 0
    s_waitcnt lgkmcnt(0)
    s_add_u32 s90, s32, 0x01010101
    s_getreg_b32 s62, hwreg(HW_REG_XCC_ID)
    s_and_b32 s62, s62, 15
    s_and_b32 s90, s90, -16
    s_or_b32 s90, s90, s62
    v_mov_b32 v246, 0
    v_mov_b32 v247, s90
    s_mov_b32 exec_lo, 0x1
    s_mov_b32 exec_hi, 0x0
    global_store_dword v246, v247, s[60:61]
    s_mov_b64 exec, -1
L_skip_90:
    s_mov_b32 s90, 0
    s_waitcnt lgkmcnt(0)
    s_bfe_u32 s56, s55, 0x40010
    s_bfe_u32 s58, s55, 0x40014
    s_bfe_u32 s53, s55, 0x40018
    s_lshr_b32 s54, s55, 28
    s_and_b32 s55, s55, 0xffff
    s_mul_i32 s62, s3, 5
    s_add_u32 s55, s55, s62
    s_min_u32 s62, s3, s56
    s_add_u32 s55, s55, s62
    s_min_u32 s62, s3, s58
    s_add_u32 s55, s55, s62
    s_lshl_b32 s62, s53, 21
    s_lshl_b32 s63, s55, 12
    s_add_u32 s62, s62, s63
    s_add_u32 s44, s18, s62
    s_addc_u32 s45, s19, 0
    s_add_u32 s46, s20, s62
    s_addc_u32 s47, s21, 0
    v_bfe_u32 v98, v0, 1, 1
    v_lshlrev_b32 v98, 11, v98
    v_bfe_u32 v99, v0, 2, 2
    v_lshl_add_u32 v98, v99, 8, v98
    v_lshl_add_u32 v98, v2, 5, v98
    v_and_b32 v99, 1, v0
    v_lshl_add_u32 v96, v99, 4, v98
    v_lshlrev_b32 v97, 4, v0
    v_lshlrev_b32 v98, 10, v2
    v_lshl_add_u32 v98, v1, 4, v98
    v_mov_b32 v124, 0
    v_mov_b32 v125, 0
    v_mov_b32 v126, 0
    v_mov_b32 v127, 0
    v_mov_b32 v123, 9728
    ds_write_b128 v123, v[124:127]
    global_load_dwordx4 v[160:163], v96, s[44:45] offset:0 nt
    v_lshlrev_b32 v4, 5, v1
    v_lshl_add_u32 v4, v2, 9, v4
    s_lshl_b32 s62, s3, 10
    v_add_u32 v4, s62, v4
    s_lshr_b32 s90, s100, 4
    s_cmp_eq_u32 s3, 7
    s_cbranch_scc0 L_skip_91
    s_and_b32 s62, s90, 7
    s_lshl_b32 s62, s62, 7
    s_add_u32 s60, s30, s62
    s_addc_u32 s61, s31, 0
    s_add_u32 s60, s60, 638976
    s_addc_u32 s61, s61, 0
    v_and_b32 v245, 31, v0
    v_lshlrev_b32 v245, 2, v245
    global_load_dword v245, v245, s[60:61] sc1
L_skip_91:
    s_mov_b32 s90, 0
    s_waitcnt vmcnt(5)
    v_perm_b32 v48, v20, v16, s38
    v_perm_b32 v49, v28, v24, s38
    s_nop 1
    v_mfma_f32_16x16x16_bf16 v[64:67], v[8:9], v[48:49], 0
    v_perm_b32 v50, v20, v16, s39
    v_perm_b32 v51, v28, v24, s39
    s_nop 1
    v_mfma_f32_16x16x16_bf16 v[68:71], v[8:9], v[50:51], 0
    v_perm_b32 v52, v21, v17, s38
    v_perm_b32 v53, v29, v25, s38
    s_nop 1
    v_mfma_f32_16x16x16_bf16 v[72:75], v[8:9], v[52:53], 0
    v_perm_b32 v54, v21, v17, s39
    v_perm_b32 v55, v29, v25, s39
    s_nop 1
    v_mfma_f32_16x16x16_bf16 v[76:79], v[8:9], v[54:55], 0
    v_perm_b32 v48, v22, v18, s38
    v_perm_b32 v49, v30, v26, s38
    s_nop 1
    v_mfma_f32_16x16x16_bf16 v[80:83], v[8:9], v[48:49], 0
    v_perm_b32 v50, v22, v18, s39
    v_perm_b32 v51, v30, v26, s39
    s_nop 1
    v_mfma_f32_16x16x16_bf16 v[84:87], v[8:9], v[50:51], 0
    v_perm_b32 v52, v23, v19, s38
    v_perm_b32 v53, v31, v27, s38
    s_nop 1
    v_mfma_f32_16x16x16_bf16 v[88:91], v[8:9], v[52:53], 0
    v_perm_b32 v54, v23, v19, s39
    v_perm_b32 v55, v31, v27, s39
    s_nop 1
    v_mfma_f32_16x16x16_bf16 v[92:95], v[8:9], v[54:55], 0
    s_mov_b32 exec_lo, 0xffffffff
    s_mov_b32 exec_hi, 0x0
    ds_write2_b32 v4, v64, v68 offset0:0 offset1:1
    ds_write2_b32 v4, v72, v76 offset0:2 offset1:3
    ds_write2_b32 v4, v80, v84 offset0:4 offset1:5
    s_nop 2
    ds_write2_b32 v4, v88, v92 offset0:6 offset1:7
    s_mov_b64 exec, -1
    s_waitcnt lgkmcnt(0)
    s_add_u32 s33, s32, 0x01010101
    v_mov_b32 v3, s33
    s_lshr_b32 s49, s33, 16
    s_and_b32 s49, s49, 0xff00
    s_and_b32 s50, s33, 0xff
    s_or_b32 s49, s49, s50
    s_mov_b32 s50, 0xffffff00
    s_getreg_b32 s62, hwreg(HW_REG_XCC_ID)
    s_and_b32 s62, s62, 15
    s_and_b32 s33, s33, -16
    s_or_b32 s33, s33, s62
    s_barrier
    s_cmp_eq_u32 s3, 7
    s_cbranch_scc0 L_skip_92
    v_lshlrev_b32 v4, 4, v0
    ds_read_b128 v[64:67], v4 offset:0
    ds_read_b128 v[68:71], v4 offset:1024
    ds_read_b128 v[72:75], v4 offset:2048
    ds_read_b128 v[76:79], v4 offset:3072
    ds_read_b128 v[80:83], v4 offset:4096
    ds_read_b128 v[84:87], v4 offset:5120
    ds_read_b128 v[88:91], v4 offset:6144
    ds_read_b128 v[92:95], v4 offset:7168
    s_lshl_b32 s62, s100, 10
    s_add_u32 s42, s30, s62
    s_addc_u32 s43, s31, 0
    s_add_u32 s42, s42, 65536
    s_addc_u32 s43, s43, 0
    s_waitcnt lgkmcnt(0)
    v_add_f32 v64, v64, v80
    v_add_f32 v65, v65, v81
    v_add_f32 v66, v66, v82
    v_add_f32 v67, v67, v83
    v_add_f32 v68, v68, v84
    v_add_f32 v69, v69, v85
    v_add_f32 v70, v70, v86
    v_add_f32 v71, v71, v87
    v_add_f32 v72, v72, v88
    v_add_f32 v73, v73, v89
    v_add_f32 v74, v74, v90
    v_add_f32 v75, v75, v91
    v_add_f32 v76, v76, v92
    v_add_f32 v77, v77, v93
    v_add_f32 v78, v78, v94
    v_add_f32 v79, v79, v95
    v_add_f32 v64, v64, v72
    v_add_f32 v65, v65, v73
    v_add_f32 v66, v66, v74
    v_add_f32 v67, v67, v75
    v_add_f32 v68, v68, v76
    v_add_f32 v69, v69, v77
    v_add_f32 v70, v70, v78
    v_add_f32 v71, v71, v79
    v_add_f32 v64, v64, v68
    v_add_f32 v65, v65, v69
    v_add_f32 v66, v66, v70
    v_add_f32 v67, v67, v71
    v_perm_b32 v64, v64, v3, s34
    v_perm_b32 v65, v65, v3, s35
    v_perm_b32 v66, v66, v3, s36
    v_perm_b32 v67, v67, v3, s37
    s_waitcnt vmcnt(0)
    v_cmp_ne_u32 s[60:61], s33, v245
    s_nop 0
    s_cmp_eq_u64 s[60:61], 0
    s_cselect_b32 s90, 1, 0
    s_cmp_lg_u32 s90, 0
    s_cbranch_scc1 L_sl_93
    global_store_dwordx4 v4, v[64:67], s[42:43] sc1
    s_branch L_sd_94
L_sl_93:
    global_store_dwordx4 v4, v[64:67], s[42:43]
L_sd_94:
L_skip_92:
    global_load_dwordx4 v[168:171], v96, s[44:45] offset:128 nt
    s_lshr_b32 s62, s57, 2
    s_lshl_b32 s62, s62, 12
    s_and_b32 s63, s3, 3
    s_lshl_b32 s63, s63, 8
    s_add_u32 s62, s62, s63
    s_add_u32 s42, s30, s62
    s_addc_u32 s43, s31, 0
    s_add_u32 s42, s42, 65536
    s_addc_u32 s43, s43, 0
    s_waitcnt vmcnt(2)
    s_mov_b64 vcc, s[96:97]
    v_cndmask_b32_dpp v48, v148, v144, vcc quad_perm:[1,0,3,2] row_mask:0xf bank_mask:0xf
    v_xor_b32 v144, v144, v48
    v_cndmask_b32_dpp v49, v149, v145, vcc quad_perm:[1,0,3,2] row_mask:0xf bank_mask:0xf
    v_xor_b32 v145, v145, v49
    v_cndmask_b32_dpp v50, v150, v146, vcc quad_perm:[1,0,3,2] row_mask:0xf bank_mask:0xf
    v_xor_b32 v146, v146, v50
    v_cndmask_b32_dpp v51, v151, v147, vcc quad_perm:[1,0,3,2] row_mask:0xf bank_mask:0xf
    v_xor_b32 v147, v147, v51
    v_xor_b32_dpp v148, v144, v148 quad_perm:[1,0,3,2] row_mask:0xf bank_mask:0xf
    v_xor_b32_dpp v149, v145, v149 quad_perm:[1,0,3,2] row_mask:0xf bank_mask:0xf
    v_xor_b32_dpp v150, v146, v150 quad_perm:[1,0,3,2] row_mask:0xf bank_mask:0xf
    v_xor_b32_dpp v151, v147, v151 quad_perm:[1,0,3,2] row_mask:0xf bank_mask:0xf
    v_cndmask_b32_dpp v52, v156, v152, vcc quad_perm:[1,0,3,2] row_mask:0xf bank_mask:0xf
    v_xor_b32 v152, v152, v52
    v_cndmask_b32_dpp v53, v157, v153, vcc quad_perm:[1,0,3,2] row_mask:0xf bank_mask:0xf
    v_xor_b32 v153, v153, v53
    v_cndmask_b32_dpp v54, v158, v154, vcc quad_perm:[1,0,3,2] row_mask:0xf bank_mask:0xf
    v_xor_b32 v154, v154, v54
    v_cndmask_b32_dpp v55, v159, v155, vcc quad_perm:[1,0,3,2] row_mask:0xf bank_mask:0xf
    v_xor_b32 v155, v155, v55
    v_xor_b32_dpp v156, v152, v156 quad_perm:[1,0,3,2] row_mask:0xf bank_mask:0xf
    v_xor_b32_dpp v157, v153, v157 quad_perm:[1,0,3,2] row_mask:0xf bank_mask:0xf
    v_xor_b32_dpp v158, v154, v158 quad_perm:[1,0,3,2] row_mask:0xf bank_mask:0xf
    v_xor_b32_dpp v159, v155, v159 quad_perm:[1,0,3,2] row_mask:0xf bank_mask:0xf
    s_cmp_ge_u32 s3, 4
    s_cbranch_scc0 L_skip_95
    s_waitcnt vmcnt(0)
    s_mov_b32 s52, 2097152
L_poll_96:
    s_sub_u32 s52, s52, 1
    s_cbranch_scc1 L_got_97
    global_load_dwordx4 v[8:11], v98, s[42:43] offset:0 sc1
    s_waitcnt vmcnt(0)
    v_perm_b32 v4, v11, v8, s48
    v_cmp_ne_u32 s[60:61], s49, v4
    s_nop 0
    s_cmp_eq_u64 s[60:61], 0
    s_cbranch_scc0 L_poll_96
L_got_97:
    v_and_b32 v8, s50, v8
    v_and_b32 v9, s50, v9
    v_and_b32 v10, s50, v10
    v_and_b32 v11, s50, v11
    v_mov_b32 v12, v8
    v_mov_b32 v13, v9
    v_mov_b32 v14, v10
    v_mov_b32 v15, v11
    v_permlane16_swap_b32 v12, v8
    v_permlane16_swap_b32 v13, v9
    v_permlane16_swap_b32 v14, v10
    v_permlane16_swap_b32 v15, v11
    v_add_f32 v8, v8, v12
    v_add_f32 v9, v9, v13
    v_add_f32 v10, v10, v14
    v_add_f32 v11, v11, v15
    v_mov_b32 v12, v8
    v_mov_b32 v13, v9
    v_mov_b32 v14, v10
    v_mov_b32 v15, v11
    v_permlane32_swap_b32 v12, v8
    v_permlane32_swap_b32 v13, v9
    v_permlane32_swap_b32 v14, v10
    v_permlane32_swap_b32 v15, v11
    v_add_f32 v8, v8, v12
    v_add_f32 v9, v9, v13
    v_add_f32 v10, v10, v14
    v_add_f32 v11, v11, v15
    v_cvt_pk_bf16_f32 v8, v8, v9
    v_cvt_pk_bf16_f32 v9, v10, v11
    s_and_b32 s62, s3, 3
    s_lshl_b32 s62, s62, 7
    v_lshlrev_b32 v4, 3, v1
    v_add_u32 v4, s62, v4
    s_mov_b32 exec_lo, 0xffff
    s_mov_b32 exec_hi, 0x0
    ds_write_b64 v4, v[8:9] offset:9856
    v_mov_b32 v6, 1
    v_mov_b32 v7, 9736
    s_mov_b32 exec_lo, 0x1
    s_mov_b32 exec_hi, 0x0
    ds_add_u32 v7, v6
    s_mov_b64 exec, -1
L_skip_95:
    s_lshr_b32 s62, s57, 2
    s_lshl_b32 s62, s62, 10
    s_and_b32 s63, s57, 3
    s_lshl_b32 s63, s63, 8
    s_add_u32 s62, s62, s63
    s_add_u32 s42, s30, s62
    s_addc_u32 s43, s31, 0
    s_add_u32 s42, s42, 393216
    s_addc_u32 s43, s43, 0
    v_and_b32 v4, 3, v0
    v_lshlrev_b32 v4, 3, v4
    v_lshrrev_b32 v4, v4, v3
    v_bfe_u32 v5, v4, 1, 1
    v_bfe_u32 v12, v4, 0, 1
    v_lshl_or_b32 v12, v5, 16, v12
    v_bfe_u32 v5, v4, 3, 1
    v_bfe_u32 v13, v4, 2, 1
    v_lshl_or_b32 v13, v5, 16, v13
    v_bfe_u32 v5, v4, 5, 1
    v_bfe_u32 v14, v4, 4, 1
    v_lshl_or_b32 v14, v5, 16, v14
    v_bfe_u32 v5, v4, 7, 1
    v_bfe_u32 v15, v4, 6, 1
    v_lshl_or_b32 v15, v5, 16, v15
    v_mov_b32 v16, 0xfffefffe
    v_lshlrev_b32 v17, 15, v2
    v_lshl_add_u32 v17, v1, 4, v17
    v_lshlrev_b32 v5, 8, v1
    v_lshl_add_u32 v5, v2, 3, v5
    s_lshl_b32 s62, s3, 5
    v_add_u32 v5, s62, v5
    v_and_b32 v4, 1, v1
    v_lshlrev_b32 v4, 8, v4
    v_lshl_add_u32 v4, v2, 5, v4
    v_mov_b32 v7, 9736
    s_mov_b32 s52, 33554432
L_cnt_98:
    ds_read_b32 v6, v7
    s_sub_u32 s52, s52, 1
    s_cbranch_scc1 L_cntok_99
    s_waitcnt lgkmcnt(0)
    v_readfirstlane_b32 s62, v6
    s_nop 0
    s_cmp_lt_u32 s62, 4
    s_cbranch_scc1 L_cnt_98
L_cntok_99:
    ds_read_b128 v[128:131], v4 offset:9856
    ds_read_b128 v[132:135], v4 offset:9872
    ds_read_b128 v[136:139], v4 offset:9984
    ds_read_b128 v[140:143], v4 offset:10000
    s_waitcnt lgkmcnt(0)
    v_mfma_f32_16x16x32_bf16 v[8:11], v[48:51], v[128:131], 0
    v_mfma_f32_16x16x32_bf16 v[8:11], v[148:151], v[132:135], v[8:11]
    v_mfma_f32_16x16x32_bf16 v[8:11], v[52:55], v[136:139], v[8:11]
    v_mfma_f32_16x16x32_bf16 v[8:11], v[156:159], v[140:143], v[8:11]
    s_nop 7
    v_add_u32 v8, 0x10000, v8
    v_add_u32 v9, 0x10000, v9
    v_add_u32 v10, 0x10000, v10
    v_add_u32 v11, 0x10000, v11
    v_perm_b32 v8, v9, v8, s39
    v_perm_b32 v9, v11, v10, s39
    s_mov_b32 exec_lo, 0x30003
    s_mov_b32 exec_hi, 0x30003
    ds_write_b64 v5, v[8:9] offset:40960
    v_mov_b32 v6, 1
    v_mov_b32 v7, 9740
    s_mov_b32 exec_lo, 0x1
    s_mov_b32 exec_hi, 0x0
    ds_add_u32 v7, v6
    s_mov_b64 exec, -1
    s_cmp_eq_u32 s3, 3
    s_cbranch_scc0 L_skip_100
    v_mov_b32 v7, 9740
    s_mov_b32 s52, 33554432
L_cnt_101:
    ds_read_b32 v6, v7
    s_sub_u32 s52, s52, 1
    s_cbranch_scc1 L_cntok_102
    s_waitcnt lgkmcnt(0)
    v_readfirstlane_b32 s62, v6
    s_nop 0
    s_cmp_lt_u32 s62, 8
    s_cbranch_scc1 L_cnt_101
L_cntok_102:
    ds_read_b128 v[8:11], v97 offset:40960
    s_waitcnt lgkmcnt(0)
    v_and_or_b32 v8, v8, v16, v12
    v_and_or_b32 v9, v9, v16, v13
    v_and_or_b32 v10, v10, v16, v14
    v_and_or_b32 v11, v11, v16, v15
    s_mov_b32 exec_lo, 0xffffffff
    s_mov_b32 exec_hi, 0x0
    global_store_dwordx4 v17, v[8:11], s[42:43] sc1
    s_mov_b64 exec, -1
L_skip_100:
    s_and_b32 s62, s53, 7
    s_lshl_b32 s62, s62, 14
    s_lshr_b32 s63, s3, 1
    s_lshl_b32 s63, s63, 12
    s_add_u32 s62, s62, s63
    s_lshr_b32 s63, s53, 3
    s_lshl_b32 s63, s63, 9
    s_add_u32 s62, s62, s63
    s_and_b32 s63, s3, 1
    s_lshl_b32 s63, s63, 8
    s_add_u32 s62, s62, s63
    s_add_u32 s40, s30, s62
    s_addc_u32 s41, s31, 0
    s_add_u32 s40, s40, 196608
    s_addc_u32 s41, s41, 0
    s_waitcnt vmcnt(2)
    global_load_dwordx4 v[164:167], v96, s[44:45] offset:1024 nt
    s_waitcnt vmcnt(2)
    global_load_dwordx4 v[172:175], v96, s[44:45] offset:1152 nt
    s_add_u32 s44, s44, 4096
    s_addc_u32 s45, s45, 0
    s_waitcnt vmcnt(2)
    global_load_dwordx4 v[176:179], v96, s[44:45] offset:0 nt
    s_waitcnt vmcnt(2)
    global_load_dwordx4 v[184:187], v96, s[44:45] offset:128 nt
    s_waitcnt vmcnt(2)
    global_load_dwordx4 v[180:183], v96, s[44:45] offset:1024 nt
    s_waitcnt vmcnt(2)
    global_load_dwordx4 v[188:191], v96, s[44:45] offset:1152 nt
    s_add_u32 s44, s44, 4096
    s_addc_u32 s45, s45, 0
    s_cmp_ge_u32 s3, 6
    s_cbranch_scc0 L_skip_103
    s_and_b32 s62, s53, 7
    s_lshl_b32 s62, s62, 7
    s_add_u32 s60, s30, s62
    s_addc_u32 s61, s31, 0
    s_add_u32 s60, s60, 638976
    s_addc_u32 s61, s61, 0
    v_and_b32 v12, 31, v0
    v_lshlrev_b32 v12, 2, v12
    global_load_dword v12, v12, s[60:61] sc1
L_skip_103:
    global_load_dwordx4 v[8:11], v98, s[40:41] offset:0 sc1
    s_waitcnt vmcnt(5)
    global_load_dwordx4 v[192:195], v96, s[44:45] offset:0 nt
    s_waitcnt vmcnt(5)
    global_load_dwordx4 v[200:203], v96, s[44:45] offset:128 nt
    s_waitcnt vmcnt(5)
    global_load_dwordx4 v[196:199], v96, s[44:45] offset:1024 nt
    s_waitcnt vmcnt(5)
    global_load_dwordx4 v[204:207], v96, s[44:45] offset:1152 nt
    s_add_u32 s44, s44, 4096
    s_addc_u32 s45, s45, 0
    s_waitcnt vmcnt(5)
    global_load_dwordx4 v[208:211], v96, s[44:45] offset:0 nt
    s_waitcnt vmcnt(5)
    global_load_dwordx4 v[216:219], v96, s[44:45] offset:128 nt
    s_waitcnt vmcnt(5)
    global_load_dwordx4 v[212:215], v96, s[44:45] offset:1024 nt
    s_waitcnt vmcnt(5)
    global_load_dwordx4 v[220:223], v96, s[44:45] offset:1152 nt
    s_add_u32 s44, s44, 4096
    s_addc_u32 s45, s45, 0
    s_waitcnt vmcnt(5)
    global_load_dwordx4 v[224:227], v96, s[44:45] offset:0 nt
    s_waitcnt vmcnt(5)
    global_load_dwordx4 v[232:235], v96, s[44:45] offset:128 nt
    s_waitcnt vmcnt(5)
    global_load_dwordx4 v[228:231], v96, s[44:45] offset:1024 nt
    s_waitcnt vmcnt(5)
    global_load_dwordx4 v[236:239], v96, s[44:45] offset:1152 nt
    s_add_u32 s44, s44, 4096
    s_addc_u32 s45, s45, 0
    s_mov_b32 s52, 2097152
    s_waitcnt vmcnt(12)
    v_perm_b32 v5, v11, v8, s48
    v_cmp_ne_u32 s[60:61], s49, v5
    s_nop 0
    s_cmp_eq_u64 s[60:61], 0
    s_cbranch_scc1 L_got_105
L_poll_104:
    s_sub_u32 s52, s52, 1
    s_cbranch_scc1 L_got_105
    global_load_dwordx4 v[8:11], v98, s[40:41] offset:0 sc1
    s_waitcnt vmcnt(0)
    v_perm_b32 v5, v11, v8, s48
    v_cmp_ne_u32 s[60:61], s49, v5
    s_nop 0
    s_cmp_eq_u64 s[60:61], 0
    s_cbranch_scc0 L_poll_104
L_got_105:
    s_cmp_ge_u32 s3, 6
    s_cbranch_scc0 L_skip_106
    v_cmp_ne_u32 s[60:61], s33, v12
    s_nop 0
    s_cmp_eq_u64 s[60:61], 0
    s_cselect_b32 s90, 1, 0
L_skip_106:
    v_and_b32 v8, s50, v8
    v_and_b32 v9, s50, v9
    v_and_b32 v10, s50, v10
    v_and_b32 v11, s50, v11
    v_mov_b32 v48, v8
    v_mov_b32 v49, v9
    v_mov_b32 v50, v10
    v_mov_b32 v51, v11
    v_permlane16_swap_b32 v48, v8
    v_permlane16_swap_b32 v49, v9
    v_permlane16_swap_b32 v50, v10
    v_permlane16_swap_b32 v51, v11
    v_add_f32 v8, v8, v48
    v_add_f32 v9, v9, v49
    v_add_f32 v10, v10, v50
    v_add_f32 v11, v11, v51
    v_mov_b32 v48, v8
    v_mov_b32 v49, v9
    v_mov_b32 v50, v10
    v_mov_b32 v51, v11
    v_permlane32_swap_b32 v48, v8
    v_permlane32_swap_b32 v49, v9
    v_permlane32_swap_b32 v50, v10
    v_permlane32_swap_b32 v51, v11
    v_add_f32 v8, v8, v48
    v_add_f32 v9, v9, v49
    v_add_f32 v10, v10, v50
    v_add_f32 v11, v11, v51
    v_cvt_pk_bf16_f32 v8, v8, v9
    v_cvt_pk_bf16_f32 v9, v10, v11
    s_lshl_b32 s62, s3, 7
    v_lshlrev_b32 v4, 3, v1
    v_add_u32 v4, s62, v4
    s_mov_b32 exec_lo, 0xffff
    s_mov_b32 exec_hi, 0x0
    ds_write_b64 v4, v[8:9] offset:8192
    v_mov_b32 v6, 1
    v_mov_b32 v7, 9728
    s_mov_b32 exec_lo, 0x1
    s_mov_b32 exec_hi, 0x0
    ds_add_u32 v7, v6
    s_mov_b64 exec, -1
    s_cmp_lt_u32 s3, s56
    s_cbranch_scc0 L_skip_107
    s_waitcnt vmcnt(5)
    global_load_dwordx4 v[240:243], v96, s[44:45] offset:0 nt
    s_waitcnt vmcnt(5)
    global_load_dwordx4 v[248:251], v96, s[44:45] offset:128 nt
    s_waitcnt vmcnt(5)
    global_load_dwordx4 v[244:247], v96, s[44:45] offset:1024 nt
    s_waitcnt vmcnt(5)
    global_load_dwordx4 v[252:255], v96, s[44:45] offset:1152 nt
    s_add_u32 s44, s44, 4096
    s_addc_u32 s45, s45, 0
L_skip_107:
    s_cmp_lt_u32 s3, s58
    s_cbranch_scc0 L_skip_108
    s_waitcnt vmcnt(5)
    global_load_dwordx4 v[144:147], v96, s[44:45] offset:0 nt
    s_waitcnt vmcnt(5)
    global_load_dwordx4 v[152:155], v96, s[44:45] offset:128 nt
    s_waitcnt vmcnt(5)
    global_load_dwordx4 v[148:151], v96, s[44:45] offset:1024 nt
    s_waitcnt vmcnt(5)
    global_load_dwordx4 v[156:159], v96, s[44:45] offset:1152 nt
    s_add_u32 s44, s44, 4096
    s_addc_u32 s45, s45, 0
L_skip_108:
    v_mov_b32 v7, 9728
    s_mov_b32 s52, 33554432
L_cnt_109:
    ds_read_b32 v6, v7
    s_sub_u32 s52, s52, 1
    s_cbranch_scc1 L_cntok_110
    s_waitcnt lgkmcnt(0)
    v_readfirstlane_b32 s62, v6
    s_nop 0
    s_cmp_lt_u32 s62, 8
    s_cbranch_scc1 L_cnt_109
L_cntok_110:
    v_lshrrev_b32 v4, 2, v1
    v_lshlrev_b32 v4, 8, v4
    v_lshl_add_u32 v4, v2, 5, v4
    ds_read_b128 v[128:131], v4 offset:8192
    ds_read_b128 v[132:135], v4 offset:8208
    ds_read_b128 v[136:139], v4 offset:8320
    ds_read_b128 v[140:143], v4 offset:8336
    v_mov_b32 v120, 0xff800000
    v_mov_b32 v121, 0xff800000
    v_mov_b32 v122, 0xff800000
    v_mov_b32 v123, 0xff800000
    v_mov_b32 v124, 0xff800000
    v_mov_b32 v125, 0xff800000
    v_mov_b32 v126, 0xff800000
    v_mov_b32 v127, 0xff800000
    s_waitcnt vmcnt(7)
    global_load_dwordx4 v[16:19], v97, s[46:47] offset:0 nt
    s_waitcnt vmcnt(7)
    global_load_dwordx4 v[20:23], v97, s[46:47] offset:1024 nt
    s_waitcnt vmcnt(7)
    global_load_dwordx4 v[24:27], v97, s[46:47] offset:2048 nt
    s_waitcnt vmcnt(7)
    global_load_dwordx4 v[28:31], v97, s[46:47] offset:3072 nt
    s_add_u32 s46, s46, 4096
    s_addc_u32 s47, s47, 0
    s_waitcnt lgkmcnt(0)
    s_waitcnt vmcnt(21)
    s_mov_b64 vcc, s[96:97]
    v_cndmask_b32_dpp v48, v164, v160, vcc quad_perm:[1,0,3,2] row_mask:0xf bank_mask:0xf
    v_xor_b32 v160, v160, v48
    v_cndmask_b32_dpp v49, v165, v161, vcc quad_perm:[1,0,3,2] row_mask:0xf bank_mask:0xf
    v_xor_b32 v161, v161, v49
    v_cndmask_b32_dpp v50, v166, v162, vcc quad_perm:[1,0,3,2] row_mask:0xf bank_mask:0xf
    v_xor_b32 v162, v162, v50
    v_cndmask_b32_dpp v51, v167, v163, vcc quad_perm:[1,0,3,2] row_mask:0xf bank_mask:0xf
    v_xor_b32 v163, v163, v51
    v_xor_b32_dpp v164, v160, v164 quad_perm:[1,0,3,2] row_mask:0xf bank_mask:0xf
    v_xor_b32_dpp v165, v161, v165 quad_perm:[1,0,3,2] row_mask:0xf bank_mask:0xf
    v_xor_b32_dpp v166, v162, v166 quad_perm:[1,0,3,2] row_mask:0xf bank_mask:0xf
    v_xor_b32_dpp v167, v163, v167 quad_perm:[1,0,3,2] row_mask:0xf bank_mask:0xf
    v_cndmask_b32_dpp v52, v172, v168, vcc quad_perm:[1,0,3,2] row_mask:0xf bank_mask:0xf
    v_xor_b32 v168, v168, v52
    v_cndmask_b32_dpp v53, v173, v169, vcc quad_perm:[1,0,3,2] row_mask:0xf bank_mask:0xf
    v_xor_b32 v169, v169, v53
    v_cndmask_b32_dpp v54, v174, v170, vcc quad_perm:[1,0,3,2] row_mask:0xf bank_mask:0xf
    v_xor_b32 v170, v170, v54
    v_cndmask_b32_dpp v55, v175, v171, vcc quad_perm:[1,0,3,2] row_mask:0xf bank_mask:0xf
    v_xor_b32 v171, v171, v55
    v_xor_b32_dpp v172, v168, v172 quad_perm:[1,0,3,2] row_mask:0xf bank_mask:0xf
    v_xor_b32_dpp v173, v169, v173 quad_perm:[1,0,3,2] row_mask:0xf bank_mask:0xf
    v_xor_b32_dpp v174, v170, v174 quad_perm:[1,0,3,2] row_mask:0xf bank_mask:0xf
    v_xor_b32_dpp v175, v171, v175 quad_perm:[1,0,3,2] row_mask:0xf bank_mask:0xf
    v_mfma_f32_16x16x32_bf16 v[100:103], v[48:51], v[128:131], 0
    v_mfma_f32_16x16x32_bf16 v[100:103], v[164:167], v[132:135], v[100:103]
    v_mfma_f32_16x16x32_bf16 v[100:103], v[52:55], v[136:139], v[100:103]
    v_mfma_f32_16x16x32_bf16 v[100:103], v[172:175], v[140:143], v[100:103]
    s_waitcnt vmcnt(17)
    s_mov_b64 vcc, s[96:97]
    v_cndmask_b32_dpp v56, v180, v176, vcc quad_perm:[1,0,3,2] row_mask:0xf bank_mask:0xf
    v_xor_b32 v176, v176, v56
    v_cndmask_b32_dpp v57, v181, v177, vcc quad_perm:[1,0,3,2] row_mask:0xf bank_mask:0xf
    v_xor_b32 v177, v177, v57
    v_cndmask_b32_dpp v58, v182, v178, vcc quad_perm:[1,0,3,2] row_mask:0xf bank_mask:0xf
    v_xor_b32 v178, v178, v58
    v_cndmask_b32_dpp v59, v183, v179, vcc quad_perm:[1,0,3,2] row_mask:0xf bank_mask:0xf
    v_xor_b32 v179, v179, v59
    v_xor_b32_dpp v180, v176, v180 quad_perm:[1,0,3,2] row_mask:0xf bank_mask:0xf
    v_xor_b32_dpp v181, v177, v181 quad_perm:[1,0,3,2] row_mask:0xf bank_mask:0xf
    v_xor_b32_dpp v182, v178, v182 quad_perm:[1,0,3,2] row_mask:0xf bank_mask:0xf
    v_xor_b32_dpp v183, v179, v183 quad_perm:[1,0,3,2] row_mask:0xf bank_mask:0xf
    v_cndmask_b32_dpp v60, v188, v184, vcc quad_perm:[1,0,3,2] row_mask:0xf bank_mask:0xf
    v_xor_b32 v184, v184, v60
    v_cndmask_b32_dpp v61, v189, v185, vcc quad_perm:[1,0,3,2] row_mask:0xf bank_mask:0xf
    v_xor_b32 v185, v185, v61
    v_cndmask_b32_dpp v62, v190, v186, vcc quad_perm:[1,0,3,2] row_mask:0xf bank_mask:0xf
    v_xor_b32 v186, v186, v62
    v_cndmask_b32_dpp v63, v191, v187, vcc quad_perm:[1,0,3,2] row_mask:0xf bank_mask:0xf
    v_xor_b32 v187, v187, v63
    v_xor_b32_dpp v188, v184, v188 quad_perm:[1,0,3,2] row_mask:0xf bank_mask:0xf
    v_xor_b32_dpp v189, v185, v189 quad_perm:[1,0,3,2] row_mask:0xf bank_mask:0xf
    v_xor_b32_dpp v190, v186, v190 quad_perm:[1,0,3,2] row_mask:0xf bank_mask:0xf
    v_xor_b32_dpp v191, v187, v191 quad_perm:[1,0,3,2] row_mask:0xf bank_mask:0xf
    v_mfma_f32_16x16x32_bf16 v[104:107], v[56:59], v[128:131], 0
    v_mfma_f32_16x16x32_bf16 v[104:107], v[180:183], v[132:135], v[104:107]
    v_mfma_f32_16x16x32_bf16 v[104:107], v[60:63], v[136:139], v[104:107]
    v_mfma_f32_16x16x32_bf16 v[104:107], v[188:191], v[140:143], v[104:107]
    s_waitcnt vmcnt(7)
    global_load_dwordx4 v[32:35], v97, s[46:47] offset:0 nt
    s_waitcnt vmcnt(7)
    global_load_dwordx4 v[36:39], v97, s[46:47] offset:1024 nt
    s_waitcnt vmcnt(7)
    global_load_dwordx4 v[40:43], v97, s[46:47] offset:2048 nt
    s_waitcnt vmcnt(7)
    global_load_dwordx4 v[44:47], v97, s[46:47] offset:3072 nt
    s_add_u32 s46, s46, 4096
    s_addc_u32 s47, s47, 0
    s_waitcnt vmcnt(16)
    s_mov_b64 vcc, s[96:97]
    v_cndmask_b32_dpp v48, v196, v192, vcc quad_perm:[1,0,3,2] row_mask:0xf bank_mask:0xf
    v_xor_b32 v192, v192, v48
    v_cndmask_b32_dpp v49, v197, v193, vcc quad_perm:[1,0,3,2] row_mask:0xf bank_mask:0xf
    v_xor_b32 v193, v193, v49
    v_cndmask_b32_dpp v50, v198, v194, vcc quad_perm:[1,0,3,2] row_mask:0xf bank_mask:0xf
    v_xor_b32 v194, v194, v50
    v_cndmask_b32_dpp v51, v199, v195, vcc quad_perm:[1,0,3,2] row_mask:0xf bank_mask:0xf
    v_xor_b32 v195, v195, v51
    v_xor_b32_dpp v196, v192, v196 quad_perm:[1,0,3,2] row_mask:0xf bank_mask:0xf
    v_xor_b32_dpp v197, v193, v197 quad_perm:[1,0,3,2] row_mask:0xf bank_mask:0xf
    v_xor_b32_dpp v198, v194, v198 quad_perm:[1,0,3,2] row_mask:0xf bank_mask:0xf
    v_xor_b32_dpp v199, v195, v199 quad_perm:[1,0,3,2] row_mask:0xf bank_mask:0xf
    v_cndmask_b32_dpp v52, v204, v200, vcc quad_perm:[1,0,3,2] row_mask:0xf bank_mask:0xf
    v_xor_b32 v200, v200, v52
    v_cndmask_b32_dpp v53, v205, v201, vcc quad_perm:[1,0,3,2] row_mask:0xf bank_mask:0xf
    v_xor_b32 v201, v201, v53
    v_cndmask_b32_dpp v54, v206, v202, vcc quad_perm:[1,0,3,2] row_mask:0xf bank_mask:0xf
    v_xor_b32 v202, v202, v54
    v_cndmask_b32_dpp v55, v207, v203, vcc quad_perm:[1,0,3,2] row_mask:0xf bank_mask:0xf
    v_xor_b32 v203, v203, v55
    v_xor_b32_dpp v204, v200, v204 quad_perm:[1,0,3,2] row_mask:0xf bank_mask:0xf
    v_xor_b32_dpp v205, v201, v205 quad_perm:[1,0,3,2] row_mask:0xf bank_mask:0xf
    v_xor_b32_dpp v206, v202, v206 quad_perm:[1,0,3,2] row_mask:0xf bank_mask:0xf
    v_xor_b32_dpp v207, v203, v207 quad_perm:[1,0,3,2] row_mask:0xf bank_mask:0xf
    v_mfma_f32_16x16x32_bf16 v[108:111], v[48:51], v[128:131], 0
    v_mfma_f32_16x16x32_bf16 v[108:111], v[196:199], v[132:135], v[108:111]
    v_mfma_f32_16x16x32_bf16 v[108:111], v[52:55], v[136:139], v[108:111]
    v_mfma_f32_16x16x32_bf16 v[108:111], v[204:207], v[140:143], v[108:111]
    s_waitcnt vmcnt(12)
    s_mov_b64 vcc, s[96:97]
    v_cndmask_b32_dpp v56, v212, v208, vcc quad_perm:[1,0,3,2] row_mask:0xf bank_mask:0xf
    v_xor_b32 v208, v208, v56
    v_cndmask_b32_dpp v57, v213, v209, vcc quad_perm:[1,0,3,2] row_mask:0xf bank_mask:0xf
    v_xor_b32 v209, v209, v57
    v_cndmask_b32_dpp v58, v214, v210, vcc quad_perm:[1,0,3,2] row_mask:0xf bank_mask:0xf
    v_xor_b32 v210, v210, v58
    v_cndmask_b32_dpp v59, v215, v211, vcc quad_perm:[1,0,3,2] row_mask:0xf bank_mask:0xf
    v_xor_b32 v211, v211, v59
    v_xor_b32_dpp v212, v208, v212 quad_perm:[1,0,3,2] row_mask:0xf bank_mask:0xf
    v_xor_b32_dpp v213, v209, v213 quad_perm:[1,0,3,2] row_mask:0xf bank_mask:0xf
    v_xor_b32_dpp v214, v210, v214 quad_perm:[1,0,3,2] row_mask:0xf bank_mask:0xf
    v_xor_b32_dpp v215, v211, v215 quad_perm:[1,0,3,2] row_mask:0xf bank_mask:0xf
    v_cndmask_b32_dpp v60, v220, v216, vcc quad_perm:[1,0,3,2] row_mask:0xf bank_mask:0xf
    v_xor_b32 v216, v216, v60
    v_cndmask_b32_dpp v61, v221, v217, vcc quad_perm:[1,0,3,2] row_mask:0xf bank_mask:0xf
    v_xor_b32 v217, v217, v61
    v_cndmask_b32_dpp v62, v222, v218, vcc quad_perm:[1,0,3,2] row_mask:0xf bank_mask:0xf
    v_xor_b32 v218, v218, v62
    v_cndmask_b32_dpp v63, v223, v219, vcc quad_perm:[1,0,3,2] row_mask:0xf bank_mask:0xf
    v_xor_b32 v219, v219, v63
    v_xor_b32_dpp v220, v216, v220 quad_perm:[1,0,3,2] row_mask:0xf bank_mask:0xf
    v_xor_b32_dpp v221, v217, v221 quad_perm:[1,0,3,2] row_mask:0xf bank_mask:0xf
    v_xor_b32_dpp v222, v218, v222 quad_perm:[1,0,3,2] row_mask:0xf bank_mask:0xf
    v_xor_b32_dpp v223, v219, v223 quad_perm:[1,0,3,2] row_mask:0xf bank_mask:0xf
    v_mfma_f32_16x16x32_bf16 v[112:115], v[56:59], v[128:131], 0
    v_mfma_f32_16x16x32_bf16 v[112:115], v[212:215], v[132:135], v[112:115]
    v_mfma_f32_16x16x32_bf16 v[112:115], v[60:63], v[136:139], v[112:115]
    v_mfma_f32_16x16x32_bf16 v[112:115], v[220:223], v[140:143], v[112:115]
    s_waitcnt vmcnt(7)
    global_load_dwordx4 v[160:163], v97, s[46:47] offset:0 nt
    s_waitcnt vmcnt(7)
    global_load_dwordx4 v[164:167], v97, s[46:47] offset:1024 nt
    s_waitcnt vmcnt(7)
    global_load_dwordx4 v[168:171], v97, s[46:47] offset:2048 nt
    s_waitcnt vmcnt(7)
    global_load_dwordx4 v[172:175], v97, s[46:47] offset:3072 nt
    s_add_u32 s46, s46, 4096
    s_addc_u32 s47, s47, 0
    s_waitcnt vmcnt(12)
    s_mov_b64 vcc, s[96:97]
    v_cndmask_b32_dpp v48, v228, v224, vcc quad_perm:[1,0,3,2] row_mask:0xf bank_mask:0xf
    v_xor_b32 v224, v224, v48
    v_cndmask_b32_dpp v49, v229, v225, vcc quad_perm:[1,0,3,2] row_mask:0xf bank_mask:0xf
    v_xor_b32 v225, v225, v49
    v_cndmask_b32_dpp v50, v230, v226, vcc quad_perm:[1,0,3,2] row_mask:0xf bank_mask:0xf
    v_xor_b32 v226, v226, v50
    v_cndmask_b32_dpp v51, v231, v227, vcc quad_perm:[1,0,3,2] row_mask:0xf bank_mask:0xf
    v_xor_b32 v227, v227, v51
    v_xor_b32_dpp v228, v224, v228 quad_perm:[1,0,3,2] row_mask:0xf bank_mask:0xf
    v_xor_b32_dpp v229, v225, v229 quad_perm:[1,0,3,2] row_mask:0xf bank_mask:0xf
    v_xor_b32_dpp v230, v226, v230 quad_perm:[1,0,3,2] row_mask:0xf bank_mask:0xf
    v_xor_b32_dpp v231, v227, v231 quad_perm:[1,0,3,2] row_mask:0xf bank_mask:0xf
    v_cndmask_b32_dpp v52, v236, v232, vcc quad_perm:[1,0,3,2] row_mask:0xf bank_mask:0xf
    v_xor_b32 v232, v232, v52
    v_cndmask_b32_dpp v53, v237, v233, vcc quad_perm:[1,0,3,2] row_mask:0xf bank_mask:0xf
    v_xor_b32 v233, v233, v53
    v_cndmask_b32_dpp v54, v238, v234, vcc quad_perm:[1,0,3,2] row_mask:0xf bank_mask:0xf
    v_xor_b32 v234, v234, v54
    v_cndmask_b32_dpp v55, v239, v235, vcc quad_perm:[1,0,3,2] row_mask:0xf bank_mask:0xf
    v_xor_b32 v235, v235, v55
    v_xor_b32_dpp v236, v232, v236 quad_perm:[1,0,3,2] row_mask:0xf bank_mask:0xf
    v_xor_b32_dpp v237, v233, v237 quad_perm:[1,0,3,2] row_mask:0xf bank_mask:0xf
    v_xor_b32_dpp v238, v234, v238 quad_perm:[1,0,3,2] row_mask:0xf bank_mask:0xf
    v_xor_b32_dpp v239, v235, v239 quad_perm:[1,0,3,2] row_mask:0xf bank_mask:0xf
    v_mfma_f32_16x16x32_bf16 v[116:119], v[48:51], v[128:131], 0
    v_mfma_f32_16x16x32_bf16 v[116:119], v[228:231], v[132:135], v[116:119]
    v_mfma_f32_16x16x32_bf16 v[116:119], v[52:55], v[136:139], v[116:119]
    v_mfma_f32_16x16x32_bf16 v[116:119], v[236:239], v[140:143], v[116:119]
    s_cmp_lt_u32 s3, s56
    s_cbranch_scc0 L_skip_111
    s_waitcnt vmcnt(12)
    s_mov_b64 vcc, s[96:97]
    v_cndmask_b32_dpp v56, v244, v240, vcc quad_perm:[1,0,3,2] row_mask:0xf bank_mask:0xf
    v_xor_b32 v240, v240, v56
    v_cndmask_b32_dpp v57, v245, v241, vcc quad_perm:[1,0,3,2] row_mask:0xf bank_mask:0xf
    v_xor_b32 v241, v241, v57
    v_cndmask_b32_dpp v58, v246, v242, vcc quad_perm:[1,0,3,2] row_mask:0xf bank_mask:0xf
    v_xor_b32 v242, v242, v58
    v_cndmask_b32_dpp v59, v247, v243, vcc quad_perm:[1,0,3,2] row_mask:0xf bank_mask:0xf
    v_xor_b32 v243, v243, v59
    v_xor_b32_dpp v244, v240, v244 quad_perm:[1,0,3,2] row_mask:0xf bank_mask:0xf
    v_xor_b32_dpp v245, v241, v245 quad_perm:[1,0,3,2] row_mask:0xf bank_mask:0xf
    v_xor_b32_dpp v246, v242, v246 quad_perm:[1,0,3,2] row_mask:0xf bank_mask:0xf
    v_xor_b32_dpp v247, v243, v247 quad_perm:[1,0,3,2] row_mask:0xf bank_mask:0xf
    v_cndmask_b32_dpp v60, v252, v248, vcc quad_perm:[1,0,3,2] row_mask:0xf bank_mask:0xf
    v_xor_b32 v248, v248, v60
    v_cndmask_b32_dpp v61, v253, v249, vcc quad_perm:[1,0,3,2] row_mask:0xf bank_mask:0xf
    v_xor_b32 v249, v249, v61
    v_cndmask_b32_dpp v62, v254, v250, vcc quad_perm:[1,0,3,2] row_mask:0xf bank_mask:0xf
    v_xor_b32 v250, v250, v62
    v_cndmask_b32_dpp v63, v255, v251, vcc quad_perm:[1,0,3,2] row_mask:0xf bank_mask:0xf
    v_xor_b32 v251, v251, v63
    v_xor_b32_dpp v252, v248, v252 quad_perm:[1,0,3,2] row_mask:0xf bank_mask:0xf
    v_xor_b32_dpp v253, v249, v253 quad_perm:[1,0,3,2] row_mask:0xf bank_mask:0xf
    v_xor_b32_dpp v254, v250, v254 quad_perm:[1,0,3,2] row_mask:0xf bank_mask:0xf
    v_xor_b32_dpp v255, v251, v255 quad_perm:[1,0,3,2] row_mask:0xf bank_mask:0xf
    v_mfma_f32_16x16x32_bf16 v[120:123], v[56:59], v[128:131], 0
    v_mfma_f32_16x16x32_bf16 v[120:123], v[244:247], v[132:135], v[120:123]
    v_mfma_f32_16x16x32_bf16 v[120:123], v[60:63], v[136:139], v[120:123]
    v_mfma_f32_16x16x32_bf16 v[120:123], v[252:255], v[140:143], v[120:123]
L_skip_111:
    s_cmp_lt_u32 s3, s58
    s_cbranch_scc0 L_skip_112
    s_waitcnt vmcnt(12)
    s_mov_b64 vcc, s[96:97]
    v_cndmask_b32_dpp v48, v148, v144, vcc quad_perm:[1,0,3,2] row_mask:0xf bank_mask:0xf
    v_xor_b32 v144, v144, v48
    v_cndmask_b32_dpp v49, v149, v145, vcc quad_perm:[1,0,3,2] row_mask:0xf bank_mask:0xf
    v_xor_b32 v145, v145, v49
    v_cndmask_b32_dpp v50, v150, v146, vcc quad_perm:[1,0,3,2] row_mask:0xf bank_mask:0xf
    v_xor_b32 v146, v146, v50
    v_cndmask_b32_dpp v51, v151, v147, vcc quad_perm:[1,0,3,2] row_mask:0xf bank_mask:0xf
    v_xor_b32 v147, v147, v51
    v_xor_b32_dpp v148, v144, v148 quad_perm:[1,0,3,2] row_mask:0xf bank_mask:0xf
    v_xor_b32_dpp v149, v145, v149 quad_perm:[1,0,3,2] row_mask:0xf bank_mask:0xf
    v_xor_b32_dpp v150, v146, v150 quad_perm:[1,0,3,2] row_mask:0xf bank_mask:0xf
    v_xor_b32_dpp v151, v147, v151 quad_perm:[1,0,3,2] row_mask:0xf bank_mask:0xf
    v_cndmask_b32_dpp v52, v156, v152, vcc quad_perm:[1,0,3,2] row_mask:0xf bank_mask:0xf
    v_xor_b32 v152, v152, v52
    v_cndmask_b32_dpp v53, v157, v153, vcc quad_perm:[1,0,3,2] row_mask:0xf bank_mask:0xf
    v_xor_b32 v153, v153, v53
    v_cndmask_b32_dpp v54, v158, v154, vcc quad_perm:[1,0,3,2] row_mask:0xf bank_mask:0xf
    v_xor_b32 v154, v154, v54
    v_cndmask_b32_dpp v55, v159, v155, vcc quad_perm:[1,0,3,2] row_mask:0xf bank_mask:0xf
    v_xor_b32 v155, v155, v55
    v_xor_b32_dpp v156, v152, v156 quad_perm:[1,0,3,2] row_mask:0xf bank_mask:0xf
    v_xor_b32_dpp v157, v153, v157 quad_perm:[1,0,3,2] row_mask:0xf bank_mask:0xf
    v_xor_b32_dpp v158, v154, v158 quad_perm:[1,0,3,2] row_mask:0xf bank_mask:0xf
    v_xor_b32_dpp v159, v155, v159 quad_perm:[1,0,3,2] row_mask:0xf bank_mask:0xf
    v_mfma_f32_16x16x32_bf16 v[124:127], v[48:51], v[128:131], 0
    v_mfma_f32_16x16x32_bf16 v[124:127], v[148:151], v[132:135], v[124:127]
    v_mfma_f32_16x16x32_bf16 v[124:127], v[52:55], v[136:139], v[124:127]
    v_mfma_f32_16x16x32_bf16 v[124:127], v[156:159], v[140:143], v[124:127]
L_skip_112:
    s_waitcnt vmcnt(7)
    global_load_dwordx4 v[176:179], v97, s[46:47] offset:0 nt
    s_waitcnt vmcnt(7)
    global_load_dwordx4 v[180:183], v97, s[46:47] offset:1024 nt
    s_waitcnt vmcnt(7)
    global_load_dwordx4 v[184:187], v97, s[46:47] offset:2048 nt
    s_waitcnt vmcnt(7)
    global_load_dwordx4 v[188:191], v97, s[46:47] offset:3072 nt
    s_add_u32 s46, s46, 4096
    s_addc_u32 s47, s47, 0
    v_max3_f32 v4, v100, v101, v102
    v_max3_f32 v4, v4, v103, v104
    v_max3_f32 v4, v4, v105, v106
    v_max3_f32 v4, v4, v107, v108
    v_max3_f32 v4, v4, v109, v110
    v_max3_f32 v4, v4, v111, v112
    v_max3_f32 v4, v4, v113, v114
    v_max3_f32 v4, v4, v115, v116
    v_max3_f32 v4, v4, v117, v118
    v_max3_f32 v4, v4, v119, v120
    v_max3_f32 v4, v4, v121, v122
    v_max3_f32 v4, v4, v123, v124
    v_max3_f32 v4, v4, v125, v126
    v_max_f32 v4, v4, v127
    v_mov_b32 v5, v4
    s_nop 1
    v_permlane16_swap_b32 v5, v4
    v_max_f32 v4, v4, v5
    v_mov_b32 v5, v4
    s_nop 1
    v_permlane32_swap_b32 v5, v4
    v_max_f32 v4, v4, v5
    v_mul_f32 v4, s51, v4
    v_fma_f32 v100, v100, s51, -v4
    v_fma_f32 v101, v101, s51, -v4
    v_fma_f32 v102, v102, s51, -v4
    v_fma_f32 v103, v103, s51, -v4
    v_fma_f32 v104, v104, s51, -v4
    v_fma_f32 v105, v105, s51, -v4
    v_fma_f32 v106, v106, s51, -v4
    v_fma_f32 v107, v107, s51, -v4
    v_fma_f32 v108, v108, s51, -v4
    v_fma_f32 v109, v109, s51, -v4
    v_fma_f32 v110, v110, s51, -v4
    v_fma_f32 v111, v111, s51, -v4
    v_fma_f32 v112, v112, s51, -v4
    v_fma_f32 v113, v113, s51, -v4
    v_fma_f32 v114, v114, s51, -v4
    v_fma_f32 v115, v115, s51, -v4
    v_fma_f32 v116, v116, s51, -v4
    v_fma_f32 v117, v117, s51, -v4
    v_fma_f32 v118, v118, s51, -v4
    v_fma_f32 v119, v119, s51, -v4
    v_fma_f32 v120, v120, s51, -v4
    v_fma_f32 v121, v121, s51, -v4
    v_fma_f32 v122, v122, s51, -v4
    v_fma_f32 v123, v123, s51, -v4
    v_fma_f32 v124, v124, s51, -v4
    v_fma_f32 v125, v125, s51, -v4
    v_fma_f32 v126, v126, s51, -v4
    v_fma_f32 v127, v127, s51, -v4
    v_exp_f32 v100, v100
    v_exp_f32 v101, v101
    v_exp_f32 v102, v102
    v_exp_f32 v103, v103
    v_exp_f32 v104, v104
    v_exp_f32 v105, v105
    v_exp_f32 v106, v106
    v_exp_f32 v107, v107
    v_exp_f32 v108, v108
    v_exp_f32 v109, v109
    v_exp_f32 v110, v110
    v_exp_f32 v111, v111
    v_exp_f32 v112, v112
    v_exp_f32 v113, v113
    v_exp_f32 v114, v114
    v_exp_f32 v115, v115
    v_exp_f32 v116, v116
    v_exp_f32 v117, v117
    v_exp_f32 v118, v118
    v_exp_f32 v119, v119
    v_exp_f32 v120, v120
    v_exp_f32 v121, v121
    v_exp_f32 v122, v122
    v_exp_f32 v123, v123
    v_exp_f32 v124, v124
    v_exp_f32 v125, v125
    v_exp_f32 v126, v126
    v_exp_f32 v127, v127
    v_add_f32 v5, v100, v101
    v_add_f32 v5, v5, v102
    v_add_f32 v5, v5, v103
    v_add_f32 v5, v5, v104
    v_add_f32 v5, v5, v105
    v_add_f32 v5, v5, v106
    v_add_f32 v5, v5, v107
    v_add_f32 v5, v5, v108
    v_add_f32 v5, v5, v109
    v_add_f32 v5, v5, v110
    v_add_f32 v5, v5, v111
    v_add_f32 v5, v5, v112
    v_add_f32 v5, v5, v113
    v_add_f32 v5, v5, v114
    v_add_f32 v5, v5, v115
    v_add_f32 v5, v5, v116
    v_add_f32 v5, v5, v117
    v_add_f32 v5, v5, v118
    v_add_f32 v5, v5, v119
    v_add_f32 v5, v5, v120
    v_add_f32 v5, v5, v121
    v_add_f32 v5, v5, v122
    v_add_f32 v5, v5, v123
    v_add_f32 v5, v5, v124
    v_add_f32 v5, v5, v125
    v_add_f32 v5, v5, v126
    v_add_f32 v5, v5, v127
    v_cvt_pk_bf16_f32 v100, v100, v101
    v_cvt_pk_bf16_f32 v101, v102, v103
    v_cvt_pk_bf16_f32 v102, v104, v105
    v_cvt_pk_bf16_f32 v103, v106, v107
    v_cvt_pk_bf16_f32 v104, v108, v109
    v_cvt_pk_bf16_f32 v105, v110, v111
    v_cvt_pk_bf16_f32 v106, v112, v113
    v_cvt_pk_bf16_f32 v107, v114, v115
    v_cvt_pk_bf16_f32 v108, v116, v117
    v_cvt_pk_bf16_f32 v109, v118, v119
    v_cvt_pk_bf16_f32 v110, v120, v121
    v_cvt_pk_bf16_f32 v111, v122, v123
    v_cvt_pk_bf16_f32 v112, v124, v125
    v_cvt_pk_bf16_f32 v113, v126, v127
    v_mov_b32 v6, v5
    s_nop 1
    v_permlane16_swap_b32 v6, v5
    v_add_f32 v5, v5, v6
    v_mov_b32 v6, v5
    s_nop 1
    v_permlane32_swap_b32 v6, v5
    v_add_f32 v5, v5, v6
    s_lshl_b32 s62, s3, 5
    v_lshlrev_b32 v6, 1, v1
    v_add_u32 v6, s62, v6
    s_mov_b32 exec_lo, 0x1111
    s_mov_b32 exec_hi, 0x0
    ds_write_b64 v6, v[4:5] offset:9216
    v_mov_b32 v6, 1
    v_mov_b32 v7, 9732
    s_mov_b32 exec_lo, 0x1
    s_mov_b32 exec_hi, 0x0
    ds_add_u32 v7, v6
    s_mov_b64 exec, -1
    s_waitcnt vmcnt(7)
    global_load_dwordx4 v[192:195], v97, s[46:47] offset:0 nt
    s_waitcnt vmcnt(7)
    global_load_dwordx4 v[196:199], v97, s[46:47] offset:1024 nt
    s_waitcnt vmcnt(7)
    global_load_dwordx4 v[200:203], v97, s[46:47] offset:2048 nt
    s_waitcnt vmcnt(7)
    global_load_dwordx4 v[204:207], v97, s[46:47] offset:3072 nt
    s_add_u32 s46, s46, 4096
    s_addc_u32 s47, s47, 0
    s_waitcnt vmcnt(12)
    v_perm_b32 v48, v20, v16, s38
    v_perm_b32 v49, v28, v24, s38
    v_perm_b32 v50, v36, v32, s38
    v_perm_b32 v51, v44, v40, s38
    s_nop 1
    v_mfma_f32_16x16x32_bf16 v[64:67], v[100:103], v[48:51], 0
    v_perm_b32 v52, v20, v16, s39
    v_perm_b32 v53, v28, v24, s39
    v_perm_b32 v54, v36, v32, s39
    v_perm_b32 v55, v44, v40, s39
    s_nop 1
    v_mfma_f32_16x16x32_bf16 v[68:71], v[100:103], v[52:55], 0
    v_perm_b32 v56, v21, v17, s38
    v_perm_b32 v57, v29, v25, s38
    v_perm_b32 v58, v37, v33, s38
    v_perm_b32 v59, v45, v41, s38
    s_nop 1
    v_mfma_f32_16x16x32_bf16 v[72:75], v[100:103], v[56:59], 0
    v_perm_b32 v60, v21, v17, s39
    v_perm_b32 v61, v29, v25, s39
    v_perm_b32 v62, v37, v33, s39
    v_perm_b32 v63, v45, v41, s39
    s_nop 1
    v_mfma_f32_16x16x32_bf16 v[76:79], v[100:103], v[60:63], 0
    v_perm_b32 v48, v22, v18, s38
    v_perm_b32 v49, v30, v26, s38
    v_perm_b32 v50, v38, v34, s38
    v_perm_b32 v51, v46, v42, s38
    s_nop 1
    v_mfma_f32_16x16x32_bf16 v[80:83], v[100:103], v[48:51], 0
    v_perm_b32 v52, v22, v18, s39
    v_perm_b32 v53, v30, v26, s39
    v_perm_b32 v54, v38, v34, s39
    v_perm_b32 v55, v46, v42, s39
    s_nop 1
    v_mfma_f32_16x16x32_bf16 v[84:87], v[100:103], v[52:55], 0
    v_perm_b32 v56, v23, v19, s38
    v_perm_b32 v57, v31, v27, s38
    v_perm_b32 v58, v39, v35, s38
    v_perm_b32 v59, v47, v43, s38
    s_nop 1
    v_mfma_f32_16x16x32_bf16 v[88:91], v[100:103], v[56:59], 0
    v_perm_b32 v60, v23, v19, s39
    v_perm_b32 v61, v31, v27, s39
    v_perm_b32 v62, v39, v35, s39
    v_perm_b32 v63, v47, v43, s39
    s_nop 1
    v_mfma_f32_16x16x32_bf16 v[92:95], v[100:103], v[60:63], 0
    s_cmp_lt_u32 s3, s56
    s_cbranch_scc0 L_skip_113
    s_waitcnt vmcnt(7)
    global_load_dwordx4 v[208:211], v97, s[46:47] offset:0 nt
    s_waitcnt vmcnt(7)
    global_load_dwordx4 v[212:215], v97, s[46:47] offset:1024 nt
    s_waitcnt vmcnt(7)
    global_load_dwordx4 v[216:219], v97, s[46:47] offset:2048 nt
    s_waitcnt vmcnt(7)
    global_load_dwordx4 v[220:223], v97, s[46:47] offset:3072 nt
    s_add_u32 s46, s46, 4096
    s_addc_u32 s47, s47, 0
L_skip_113:
    v_mov_b32 v7, 9732
    s_mov_b32 s52, 33554432
L_cnt_114:
    ds_read_b32 v6, v7
    s_sub_u32 s52, s52, 1
    s_cbranch_scc1 L_cntok_115
    s_waitcnt lgkmcnt(0)
    v_readfirstlane_b32 s62, v6
    s_nop 0
    s_cmp_lt_u32 s62, 8
    s_cbranch_scc1 L_cnt_114
L_cntok_115:
    v_lshlrev_b32 v6, 3, v2
    ds_read_b64 v[16:17], v6 offset:9216
    ds_read_b64 v[18:19], v6 offset:9248
    ds_read_b64 v[20:21], v6 offset:9280
    ds_read_b64 v[22:23], v6 offset:9312
    ds_read_b64 v[24:25], v6 offset:9344
    ds_read_b64 v[26:27], v6 offset:9376
    ds_read_b64 v[28:29], v6 offset:9408
    ds_read_b64 v[30:31], v6 offset:9440
    s_lshl_b32 s62, s3, 5
    v_add_u32 v6, s62, v6
    ds_read_b64 v[4:5], v6 offset:9216
    s_waitcnt lgkmcnt(0)
    v_max3_f32 v7, v16, v18, v20
    v_max3_f32 v7, v7, v22, v24
    v_max3_f32 v7, v7, v26, v28
    v_max_f32 v7, v7, v30
    v_sub_f32 v16, v16, v7
    v_sub_f32 v18, v18, v7
    v_sub_f32 v20, v20, v7
    v_sub_f32 v22, v22, v7
    v_sub_f32 v24, v24, v7
    v_sub_f32 v26, v26, v7
    v_sub_f32 v28, v28, v7
    v_sub_f32 v30, v30, v7
    v_sub_f32 v4, v4, v7
    v_exp_f32 v16, v16
    v_exp_f32 v18, v18
    v_exp_f32 v20, v20
    v_exp_f32 v22, v22
    v_exp_f32 v24, v24
    v_exp_f32 v26, v26
    v_exp_f32 v28, v28
    v_exp_f32 v30, v30
    v_exp_f32 v4, v4
    v_mul_f32 v5, v16, v17
    v_fmac_f32 v5, v18, v19
    v_fmac_f32 v5, v20, v21
    v_fmac_f32 v5, v22, v23
    v_fmac_f32 v5, v24, v25
    v_fmac_f32 v5, v26, v27
    v_fmac_f32 v5, v28, v29
    v_fmac_f32 v5, v30, v31
    v_rcp_f32 v6, v5
    v_log_f32 v5, v5
    v_mul_f32 v99, v4, v6
    s_cmp_eq_u32 s3, 7
    s_cbranch_scc0 L_skip_116
    v_add_f32 v8, v5, v7
    v_add_f32 v9, v5, v7
    v_add_f32 v10, v5, v7
    v_add_f32 v11, v5, v7
    v_perm_b32 v8, v8, v3, s34
    v_perm_b32 v9, v9, v3, s35
    v_perm_b32 v10, v10, v3, s36
    v_perm_b32 v11, v11, v3, s37
    s_and_b32 s62, s53, 7
    s_lshl_b32 s62, s62, 11
    s_lshr_b32 s63, s53, 3
    s_lshl_b32 s63, s63, 8
    s_add_u32 s62, s62, s63
    s_lshl_b32 s63, s54, 4
    s_add_u32 s62, s62, s63
    s_add_u32 s40, s30, s62
    s_addc_u32 s41, s31, 0
    s_add_u32 s40, s40, 655360
    s_addc_u32 s41, s41, 0
    v_lshlrev_b32 v4, 9, v2
    s_mov_b32 exec_lo, 0x10001
    s_mov_b32 exec_hi, 0x10001
    s_cmp_lg_u32 s90, 0
    s_cbranch_scc1 L_sl_117
    global_store_dwordx4 v4, v[8:11], s[40:41] sc1
    s_branch L_sd_118
L_sl_117:
    global_store_dwordx4 v4, v[8:11], s[40:41]
L_sd_118:
    s_mov_b64 exec, -1
L_skip_116:
    s_and_b32 s62, s53, 7
    s_lshl_b32 s62, s62, 3
    s_and_b32 s63, s3, 1
    s_lshl_b32 s63, s63, 2
    s_add_u32 s62, s62, s63
    s_lshr_b32 s63, s53, 3
    s_add_u32 s62, s62, s63
    s_mul_i32 s62, s62, 16
    s_add_u32 s62, s62, s54
    s_lshl_b32 s62, s62, 9
    s_add_u32 s40, s30, s62
    s_addc_u32 s41, s31, 0
    s_add_u32 s40, s40, 720896
    s_addc_u32 s41, s41, 0
    v_lshrrev_b32 v4, 5, v0
    v_mul_u32_u24 v4, 16384, v4
    v_and_b32 v5, 31, v0
    v_lshl_add_u32 v98, v5, 4, v4
    s_lshl_b32 s62, s3, 11
    v_lshlrev_b32 v4, 9, v2
    v_lshl_add_u32 v4, v1, 5, v4
    v_add_u32 v96, s62, v4
    s_and_b32 s62, s3, 1
    s_lshl_b32 s62, s62, 10
    v_add_u32 v16, s62, v97
    s_cmp_lt_u32 s3, s58
    s_cbranch_scc0 L_skip_119
    s_waitcnt vmcnt(7)
    global_load_dwordx4 v[224:227], v97, s[46:47] offset:0 nt
    s_waitcnt vmcnt(7)
    global_load_dwordx4 v[228:231], v97, s[46:47] offset:1024 nt
    s_waitcnt vmcnt(7)
    global_load_dwordx4 v[232:235], v97, s[46:47] offset:2048 nt
    s_waitcnt vmcnt(7)
    global_load_dwordx4 v[236:239], v97, s[46:47] offset:3072 nt
    s_add_u32 s46, s46, 4096
    s_addc_u32 s47, s47, 0
L_skip_119:
    s_waitcnt vmcnt(4)
    v_perm_b32 v48, v164, v160, s38
    v_perm_b32 v49, v172, v168, s38
    v_perm_b32 v50, v180, v176, s38
    v_perm_b32 v51, v188, v184, s38
    s_nop 1
    v_mfma_f32_16x16x32_bf16 v[64:67], v[104:107], v[48:51], v[64:67]
    v_perm_b32 v52, v164, v160, s39
    v_perm_b32 v53, v172, v168, s39
    v_perm_b32 v54, v180, v176, s39
    v_perm_b32 v55, v188, v184, s39
    s_nop 1
    v_mfma_f32_16x16x32_bf16 v[68:71], v[104:107], v[52:55], v[68:71]
    v_perm_b32 v56, v165, v161, s38
    v_perm_b32 v57, v173, v169, s38
    v_perm_b32 v58, v181, v177, s38
    v_perm_b32 v59, v189, v185, s38
    s_nop 1
    v_mfma_f32_16x16x32_bf16 v[72:75], v[104:107], v[56:59], v[72:75]
    v_perm_b32 v60, v165, v161, s39
    v_perm_b32 v61, v173, v169, s39
    v_perm_b32 v62, v181, v177, s39
    v_perm_b32 v63, v189, v185, s39
    s_nop 1
    v_mfma_f32_16x16x32_bf16 v[76:79], v[104:107], v[60:63], v[76:79]
    v_perm_b32 v48, v166, v162, s38
    v_perm_b32 v49, v174, v170, s38
    v_perm_b32 v50, v182, v178, s38
    v_perm_b32 v51, v190, v186, s38
    s_nop 1
    v_mfma_f32_16x16x32_bf16 v[80:83], v[104:107], v[48:51], v[80:83]
    v_perm_b32 v52, v166, v162, s39
    v_perm_b32 v53, v174, v170, s39
    v_perm_b32 v54, v182, v178, s39
    v_perm_b32 v55, v190, v186, s39
    s_nop 1
    v_mfma_f32_16x16x32_bf16 v[84:87], v[104:107], v[52:55], v[84:87]
    v_perm_b32 v56, v167, v163, s38
    v_perm_b32 v57, v175, v171, s38
    v_perm_b32 v58, v183, v179, s38
    v_perm_b32 v59, v191, v187, s38
    s_nop 1
    v_mfma_f32_16x16x32_bf16 v[88:91], v[104:107], v[56:59], v[88:91]
    v_perm_b32 v60, v167, v163, s39
    v_perm_b32 v61, v175, v171, s39
    v_perm_b32 v62, v183, v179, s39
    v_perm_b32 v63, v191, v187, s39
    s_nop 1
    v_mfma_f32_16x16x32_bf16 v[92:95], v[104:107], v[60:63], v[92:95]
    s_waitcnt vmcnt(0)
    v_perm_b32 v48, v196, v192, s38
    v_perm_b32 v49, v204, v200, s38
    s_nop 1
    v_mfma_f32_16x16x16_bf16 v[64:67], v[108:109], v[48:49], v[64:67]
    v_perm_b32 v52, v196, v192, s39
    v_perm_b32 v53, v204, v200, s39
    s_nop 1
    v_mfma_f32_16x16x16_bf16 v[68:71], v[108:109], v[52:53], v[68:71]
    v_perm_b32 v56, v197, v193, s38
    v_perm_b32 v57, v205, v201, s38
    s_nop 1
    v_mfma_f32_16x16x16_bf16 v[72:75], v[108:109], v[56:57], v[72:75]
    v_perm_b32 v60, v197, v193, s39
    v_perm_b32 v61, v205, v201, s39
    s_nop 1
    v_mfma_f32_16x16x16_bf16 v[76:79], v[108:109], v[60:61], v[76:79]
    v_perm_b32 v48, v198, v194, s38
    v_perm_b32 v49, v206, v202, s38
    s_nop 1
    v_mfma_f32_16x16x16_bf16 v[80:83], v[108:109], v[48:49], v[80:83]
    v_perm_b32 v52, v198, v194, s39
    v_perm_b32 v53, v206, v202, s39
    s_nop 1
    v_mfma_f32_16x16x16_bf16 v[84:87], v[108:109], v[52:53], v[84:87]
    v_perm_b32 v56, v199, v195, s38
    v_perm_b32 v57, v207, v203, s38
    s_nop 1
    v_mfma_f32_16x16x16_bf16 v[88:91], v[108:109], v[56:57], v[88:91]
    v_perm_b32 v60, v199, v195, s39
    v_perm_b32 v61, v207, v203, s39
    s_nop 1
    v_mfma_f32_16x16x16_bf16 v[92:95], v[108:109], v[60:61], v[92:95]
    s_cmp_lt_u32 s3, s56
    s_cbranch_scc0 L_skip_120
    s_waitcnt vmcnt(0)
    v_perm_b32 v48, v212, v208, s38
    v_perm_b32 v49, v220, v216, s38
    s_nop 1
    v_mfma_f32_16x16x16_bf16 v[64:67], v[110:111], v[48:49], v[64:67]
    v_perm_b32 v52, v212, v208, s39
    v_perm_b32 v53, v220, v216, s39
    s_nop 1
    v_mfma_f32_16x16x16_bf16 v[68:71], v[110:111], v[52:53], v[68:71]
    v_perm_b32 v56, v213, v209, s38
    v_perm_b32 v57, v221, v217, s38
    s_nop 1
    v_mfma_f32_16x16x16_bf16 v[72:75], v[110:111], v[56:57], v[72:75]
    v_perm_b32 v60, v213, v209, s39
    v_perm_b32 v61, v221, v217, s39
    s_nop 1
    v_mfma_f32_16x16x16_bf16 v[76:79], v[110:111], v[60:61], v[76:79]
    v_perm_b32 v48, v214, v210, s38
    v_perm_b32 v49, v222, v218, s38
    s_nop 1
    v_mfma_f32_16x16x16_bf16 v[80:83], v[110:111], v[48:49], v[80:83]
    v_perm_b32 v52, v214, v210, s39
    v_perm_b32 v53, v222, v218, s39
    s_nop 1
    v_mfma_f32_16x16x16_bf16 v[84:87], v[110:111], v[52:53], v[84:87]
    v_perm_b32 v56, v215, v211, s38
    v_perm_b32 v57, v223, v219, s38
    s_nop 1
    v_mfma_f32_16x16x16_bf16 v[88:91], v[110:111], v[56:57], v[88:91]
    v_perm_b32 v60, v215, v211, s39
    v_perm_b32 v61, v223, v219, s39
    s_nop 1
    v_mfma_f32_16x16x16_bf16 v[92:95], v[110:111], v[60:61], v[92:95]
L_skip_120:
    s_cmp_lt_u32 s3, s58
    s_cbranch_scc0 L_skip_121
    s_waitcnt vmcnt(0)
    v_perm_b32 v48, v228, v224, s38
    v_perm_b32 v49, v236, v232, s38
    s_nop 1
    v_mfma_f32_16x16x16_bf16 v[64:67], v[112:113], v[48:49], v[64:67]
    v_perm_b32 v52, v228, v224, s39
    v_perm_b32 v53, v236, v232, s39
    s_nop 1
    v_mfma_f32_16x16x16_bf16 v[68:71], v[112:113], v[52:53], v[68:71]
    v_perm_b32 v56, v229, v225, s38
    v_perm_b32 v57, v237, v233, s38
    s_nop 1
    v_mfma_f32_16x16x16_bf16 v[72:75], v[112:113], v[56:57], v[72:75]
    v_perm_b32 v60, v229, v225, s39
    v_perm_b32 v61, v237, v233, s39
    s_nop 1
    v_mfma_f32_16x16x16_bf16 v[76:79], v[112:113], v[60:61], v[76:79]
    v_perm_b32 v48, v230, v226, s38
    v_perm_b32 v49, v238, v234, s38
    s_nop 1
    v_mfma_f32_16x16x16_bf16 v[80:83], v[112:113], v[48:49], v[80:83]
    v_perm_b32 v52, v230, v226, s39
    v_perm_b32 v53, v238, v234, s39
    s_nop 1
    v_mfma_f32_16x16x16_bf16 v[84:87], v[112:113], v[52:53], v[84:87]
    v_perm_b32 v56, v231, v227, s38
    v_perm_b32 v57, v239, v235, s38
    s_nop 1
    v_mfma_f32_16x16x16_bf16 v[88:91], v[112:113], v[56:57], v[88:91]
    v_perm_b32 v60, v231, v227, s39
    v_perm_b32 v61, v239, v235, s39
    s_nop 1
    v_mfma_f32_16x16x16_bf16 v[92:95], v[112:113], v[60:61], v[92:95]
L_skip_121:
    v_mul_f32 v20, v99, v64
    v_mul_f32 v21, v99, v68
    v_mul_f32 v22, v99, v72
    v_mul_f32 v23, v99, v76
    v_mul_f32 v24, v99, v80
    v_mul_f32 v25, v99, v84
    v_mul_f32 v26, v99, v88
    s_nop 0
    v_mul_f32 v27, v99, v92
    ds_write_b128 v96, v[20:23] offset:10240
    ds_write_b128 v96, v[24:27] offset:10256
    s_waitcnt lgkmcnt(0)
    s_barrier
    s_cmp_ge_u32 s3, 6
    s_cbranch_scc0 L_skip_122
    ds_read_b128 v[20:23], v16 offset:10240
    ds_read_b128 v[24:27], v16 offset:12288
    ds_read_b128 v[28:31], v16 offset:14336
    ds_read_b128 v[32:35], v16 offset:16384
    ds_read_b128 v[36:39], v16 offset:18432
    ds_read_b128 v[40:43], v16 offset:20480
    ds_read_b128 v[44:47], v16 offset:22528
    ds_read_b128 v[48:51], v16 offset:24576
    s_waitcnt lgkmcnt(0)
    v_add_f32 v20, v20, v36
    v_add_f32 v21, v21, v37
    v_add_f32 v22, v22, v38
    v_add_f32 v23, v23, v39
    v_add_f32 v24, v24, v40
    v_add_f32 v25, v25, v41
    v_add_f32 v26, v26, v42
    v_add_f32 v27, v27, v43
    v_add_f32 v28, v28, v44
    v_add_f32 v29, v29, v45
    v_add_f32 v30, v30, v46
    v_add_f32 v31, v31, v47
    v_add_f32 v32, v32, v48
    v_add_f32 v33, v33, v49
    v_add_f32 v34, v34, v50
    v_add_f32 v35, v35, v51
    v_add_f32 v20, v20, v28
    v_add_f32 v21, v21, v29
    v_add_f32 v22, v22, v30
    v_add_f32 v23, v23, v31
    v_add_f32 v24, v24, v32
    v_add_f32 v25, v25, v33
    v_add_f32 v26, v26, v34
    v_add_f32 v27, v27, v35
    v_add_f32 v20, v20, v24
    v_add_f32 v21, v21, v25
    v_add_f32 v22, v22, v26
    v_add_f32 v23, v23, v27
    v_perm_b32 v20, v20, v3, s34
    v_perm_b32 v21, v21, v3, s35
    v_perm_b32 v22, v22, v3, s36
    v_perm_b32 v23, v23, v3, s37
    s_cmp_lg_u32 s90, 0
    s_cbranch_scc1 L_sl_123
    global_store_dwordx4 v98, v[20:23], s[40:41] sc1
    s_branch L_sd_124
L_sl_123:
    global_store_dwordx4 v98, v[20:23], s[40:41]
L_sd_124:
L_skip_122:
    s_branch L_fin
L_roleB2:
    s_and_b32 s101, s2, 7
    s_lshl_b32 s101, s101, 4
    s_lshr_b32 s63, s2, 3
    s_and_b32 s63, s63, 3
    s_add_u32 s101, s101, s63
    s_add_u32 s100, s101, 4
    s_add_u32 s101, s101, 140
    v_lshlrev_b32 v4, 15, v2
    v_lshl_add_u32 v4, v1, 4, v4
    v_bfe_u32 v5, v1, 2, 1
    v_lshlrev_b32 v5, 10, v5
    v_lshl_add_u32 v5, v2, 3, v5
    s_and_b32 s62, s100, 3
    s_lshl_b32 s62, s62, 7
    s_lshl_b32 s63, s3, 4
    s_add_u32 s62, s62, s63
    s_lshl_b32 s40, s62, 13
    s_lshr_b32 s63, s100, 2
    s_and_b32 s63, s63, 31
    s_lshl_b32 s63, s63, 8
    s_add_u32 s40, s40, s63
    s_lshl_b32 s62, s62, 1
    s_waitcnt lgkmcnt(0)
    s_add_u32 s40, s8, s40
    s_addc_u32 s41, s9, 0
    s_add_u32 s42, s4, s62
    s_addc_u32 s43, s5, 0
    global_load_dwordx2 v[8:9], v5, s[42:43]
    global_load_dwordx4 v[16:19], v4, s[40:41] offset:0 nt
    s_add_u32 s40, s40, 8192
    s_addc_u32 s41, s41, 0
    global_load_dwordx4 v[20:23], v4, s[40:41] offset:0 nt
    s_add_u32 s40, s40, 8192
    s_addc_u32 s41, s41, 0
    global_load_dwordx4 v[24:27], v4, s[40:41] offset:0 nt
    s_add_u32 s40, s40, 8192
    s_addc_u32 s41, s41, 0
    global_load_dwordx4 v[28:31], v4, s[40:41] offset:0 nt
    s_barrier
    s_and_b32 s62, s101, 3
    s_lshl_b32 s62, s62, 7
    s_lshl_b32 s63, s3, 4
    s_add_u32 s62, s62, s63
    s_lshl_b32 s40, s62, 13
    s_lshr_b32 s63, s101, 2
    s_and_b32 s63, s63, 31
    s_lshl_b32 s63, s63, 8
    s_add_u32 s40, s40, s63
    s_lshl_b32 s62, s62, 1
    s_add_u32 s40, s22, s40
    s_addc_u32 s41, s23, 0
    s_add_u32 s42, s16, s62
    s_addc_u32 s43, s17, 0
    global_load_dwordx2 v[10:11], v5, s[42:43]
    global_load_dwordx4 v[32:35], v4, s[40:41] offset:0 nt
    s_add_u32 s40, s40, 8192
    s_addc_u32 s41, s41, 0
    global_load_dwordx4 v[36:39], v4, s[40:41] offset:0 nt
    s_add_u32 s40, s40, 8192
    s_addc_u32 s41, s41, 0
    global_load_dwordx4 v[40:43], v4, s[40:41] offset:0 nt
    s_add_u32 s40, s40, 8192
    s_addc_u32 s41, s41, 0
    global_load_dwordx4 v[44:47], v4, s[40:41] offset:0 nt
    s_load_dword s32, s[30:31], 0
    s_mov_b32 s34, 0x7060500
    s_mov_b32 s35, 0x7060501
    s_mov_b32 s36, 0x7060502
    s_mov_b32 s37, 0x7060503
    s_mov_b32 s38, 0x05040100
    s_mov_b32 s39, 0x07060302
    s_mov_b32 s48, 0x0c0c0400
    s_mov_b32 s51, 0x3e0293ee
    s_mov_b32 s96, 0x55555555
    s_mov_b32 s97, 0x55555555
    s_cmp_eq_u32 s3, 1
    s_cbranch_scc0 L_skip_125
    s_and_b32 s62, s2, 7
    s_lshl_b32 s62, s62, 7
    s_lshr_b32 s63, s2, 3
    s_lshl_b32 s63, s63, 2
    s_add_u32 s62, s62, s63
    s_add_u32 s60, s30, s62
    s_addc_u32 s61, s31, 0
    s_add_u32 s60, s60, 638976
    s_addc_u32 s61, s61, 0
    s_waitcnt lgkmcnt(0)
    s_add_u32 s90, s32, 0x01010101
    s_getreg_b32 s62, hwreg(HW_REG_XCC_ID)
    s_and_b32 s62, s62, 15
    s_and_b32 s90, s90, -16
    s_or_b32 s90, s90, s62
    v_mov_b32 v246, 0
    v_mov_b32 v247, s90
    s_mov_b32 exec_lo, 0x1
    s_mov_b32 exec_hi, 0x0
    global_store_dword v246, v247, s[60:61]
    s_mov_b64 exec, -1
L_skip_125:
    s_mov_b32 s90, 0
    s_and_b32 s62, s2, 7
    s_lshl_b32 s62, s62, 2
    s_lshr_b32 s63, s2, 3
    s_and_b32 s63, s63, 3
    s_add_u32 s62, s62, s63
    s_mov_b32 s2, s62
    s_waitcnt lgkmcnt(0)
    s_bfe_u32 s56, s55, 0x40010
    s_bfe_u32 s58, s55, 0x40014
    s_bfe_u32 s53, s55, 0x40018
    s_lshr_b32 s54, s55, 28
    s_and_b32 s55, s55, 0xffff
    s_mul_i32 s62, s3, 3
    s_add_u32 s55, s55, s62
    s_min_u32 s62, s3, s56
    s_add_u32 s55, s55, s62
    s_min_u32 s62, s3, s58
    s_add_u32 s55, s55, s62
    s_lshl_b32 s62, s53, 21
    s_lshl_b32 s63, s55, 12
    s_add_u32 s62, s62, s63
    s_add_u32 s44, s18, s62
    s_addc_u32 s45, s19, 0
    s_add_u32 s46, s20, s62
    s_addc_u32 s47, s21, 0
    v_bfe_u32 v98, v0, 1, 1
    v_lshlrev_b32 v98, 11, v98
    v_bfe_u32 v99, v0, 2, 2
    v_lshl_add_u32 v98, v99, 8, v98
    v_lshl_add_u32 v98, v2, 5, v98
    v_and_b32 v99, 1, v0
    v_lshl_add_u32 v96, v99, 4, v98
    v_lshlrev_b32 v97, 4, v0
    v_lshlrev_b32 v98, 10, v2
    v_lshl_add_u32 v98, v1, 4, v98
    v_mov_b32 v124, 0
    v_mov_b32 v125, 0
    v_mov_b32 v126, 0
    v_mov_b32 v127, 0
    v_mov_b32 v123, 9728
    ds_write_b128 v123, v[124:127]
    global_load_dwordx4 v[160:163], v96, s[44:45] offset:0 nt
    v_lshlrev_b32 v4, 5, v1
    v_lshl_add_u32 v4, v2, 9, v4
    s_lshl_b32 s62, s3, 10
    v_add_u32 v4, s62, v4
    s_lshr_b32 s90, s100, 4
    s_cmp_eq_u32 s3, 7
    s_cbranch_scc0 L_skip_126
    s_and_b32 s62, s90, 7
    s_lshl_b32 s62, s62, 7
    s_add_u32 s60, s30, s62
    s_addc_u32 s61, s31, 0
    s_add_u32 s60, s60, 638976
    s_addc_u32 s61, s61, 0
    v_and_b32 v245, 31, v0
    v_lshlrev_b32 v245, 2, v245
    global_load_dword v245, v245, s[60:61] sc1
L_skip_126:
    s_mov_b32 s90, 0
    s_waitcnt vmcnt(6)
    v_perm_b32 v48, v20, v16, s38
    v_perm_b32 v49, v28, v24, s38
    s_nop 1
    v_mfma_f32_16x16x16_bf16 v[64:67], v[8:9], v[48:49], 0
    v_perm_b32 v50, v20, v16, s39
    v_perm_b32 v51, v28, v24, s39
    s_nop 1
    v_mfma_f32_16x16x16_bf16 v[68:71], v[8:9], v[50:51], 0
    v_perm_b32 v52, v21, v17, s38
    v_perm_b32 v53, v29, v25, s38
    s_nop 1
    v_mfma_f32_16x16x16_bf16 v[72:75], v[8:9], v[52:53], 0
    v_perm_b32 v54, v21, v17, s39
    v_perm_b32 v55, v29, v25, s39
    s_nop 1
    v_mfma_f32_16x16x16_bf16 v[76:79], v[8:9], v[54:55], 0
    v_perm_b32 v48, v22, v18, s38
    v_perm_b32 v49, v30, v26, s38
    s_nop 1
    v_mfma_f32_16x16x16_bf16 v[80:83], v[8:9], v[48:49], 0
    v_perm_b32 v50, v22, v18, s39
    v_perm_b32 v51, v30, v26, s39
    s_nop 1
    v_mfma_f32_16x16x16_bf16 v[84:87], v[8:9], v[50:51], 0
    v_perm_b32 v52, v23, v19, s38
    v_perm_b32 v53, v31, v27, s38
    s_nop 1
    v_mfma_f32_16x16x16_bf16 v[88:91], v[8:9], v[52:53], 0
    v_perm_b32 v54, v23, v19, s39
    v_perm_b32 v55, v31, v27, s39
    s_nop 1
    v_mfma_f32_16x16x16_bf16 v[92:95], v[8:9], v[54:55], 0
    s_mov_b32 exec_lo, 0xffffffff
    s_mov_b32 exec_hi, 0x0
    ds_write2_b32 v4, v64, v68 offset0:0 offset1:1
    ds_write2_b32 v4, v72, v76 offset0:2 offset1:3
    ds_write2_b32 v4, v80, v84 offset0:4 offset1:5
    s_nop 2
    ds_write2_b32 v4, v88, v92 offset0:6 offset1:7
    s_mov_b64 exec, -1
    s_waitcnt lgkmcnt(0)
    s_add_u32 s33, s32, 0x01010101
    v_mov_b32 v3, s33
    s_lshr_b32 s49, s33, 16
    s_and_b32 s49, s49, 0xff00
    s_and_b32 s50, s33, 0xff
    s_or_b32 s49, s49, s50
    s_mov_b32 s50, 0xffffff00
    s_getreg_b32 s62, hwreg(HW_REG_XCC_ID)
    s_and_b32 s62, s62, 15
    s_and_b32 s33, s33, -16
    s_or_b32 s33, s33, s62
    s_barrier
    s_cmp_eq_u32 s3, 7
    s_cbranch_scc0 L_skip_127
    v_lshlrev_b32 v4, 4, v0
    ds_read_b128 v[64:67], v4 offset:0
    ds_read_b128 v[68:71], v4 offset:1024
    ds_read_b128 v[72:75], v4 offset:2048
    ds_read_b128 v[76:79], v4 offset:3072
    ds_read_b128 v[80:83], v4 offset:4096
    ds_read_b128 v[84:87], v4 offset:5120
    ds_read_b128 v[88:91], v4 offset:6144
    ds_read_b128 v[92:95], v4 offset:7168
    s_lshl_b32 s62, s100, 10
    s_add_u32 s42, s30, s62
    s_addc_u32 s43, s31, 0
    s_add_u32 s42, s42, 65536
    s_addc_u32 s43, s43, 0
    s_waitcnt lgkmcnt(0)
    v_add_f32 v64, v64, v80
    v_add_f32 v65, v65, v81
    v_add_f32 v66, v66, v82
    v_add_f32 v67, v67, v83
    v_add_f32 v68, v68, v84
    v_add_f32 v69, v69, v85
    v_add_f32 v70, v70, v86
    v_add_f32 v71, v71, v87
    v_add_f32 v72, v72, v88
    v_add_f32 v73, v73, v89
    v_add_f32 v74, v74, v90
    v_add_f32 v75, v75, v91
    v_add_f32 v76, v76, v92
    v_add_f32 v77, v77, v93
    v_add_f32 v78, v78, v94
    v_add_f32 v79, v79, v95
    v_add_f32 v64, v64, v72
    v_add_f32 v65, v65, v73
    v_add_f32 v66, v66, v74
    v_add_f32 v67, v67, v75
    v_add_f32 v68, v68, v76
    v_add_f32 v69, v69, v77
    v_add_f32 v70, v70, v78
    v_add_f32 v71, v71, v79
    v_add_f32 v64, v64, v68
    v_add_f32 v65, v65, v69
    v_add_f32 v66, v66, v70
    v_add_f32 v67, v67, v71
    v_perm_b32 v64, v64, v3, s34
    v_perm_b32 v65, v65, v3, s35
    v_perm_b32 v66, v66, v3, s36
    v_perm_b32 v67, v67, v3, s37
    s_waitcnt vmcnt(0)
    v_cmp_ne_u32 s[60:61], s33, v245
    s_nop 0
    s_cmp_eq_u64 s[60:61], 0
    s_cselect_b32 s90, 1, 0
    s_cmp_lg_u32 s90, 0
    s_cbranch_scc1 L_sl_128
    global_store_dwordx4 v4, v[64:67], s[42:43] sc1
    s_branch L_sd_129
L_sl_128:
    global_store_dwordx4 v4, v[64:67], s[42:43]
L_sd_129:
L_skip_127:
    v_lshlrev_b32 v4, 5, v1
    v_lshl_add_u32 v4, v2, 9, v4
    s_lshl_b32 s62, s3, 10
    s_add_u32 s62, s62, 16384
    v_add_u32 v4, s62, v4
    s_waitcnt vmcnt(1)
    v_perm_b32 v48, v36, v32, s38
    v_perm_b32 v49, v44, v40, s38
    s_nop 1
    v_mfma_f32_16x16x16_bf16 v[64:67], v[10:11], v[48:49], 0
    v_perm_b32 v50, v36, v32, s39
    v_perm_b32 v51, v44, v40, s39
    s_nop 1
    v_mfma_f32_16x16x16_bf16 v[68:71], v[10:11], v[50:51], 0
    v_perm_b32 v52, v37, v33, s38
    v_perm_b32 v53, v45, v41, s38
    s_nop 1
    v_mfma_f32_16x16x16_bf16 v[72:75], v[10:11], v[52:53], 0
    v_perm_b32 v54, v37, v33, s39
    v_perm_b32 v55, v45, v41, s39
    s_nop 1
    v_mfma_f32_16x16x16_bf16 v[76:79], v[10:11], v[54:55], 0
    v_perm_b32 v48, v38, v34, s38
    v_perm_b32 v49, v46, v42, s38
    s_nop 1
    v_mfma_f32_16x16x16_bf16 v[80:83], v[10:11], v[48:49], 0
    v_perm_b32 v50, v38, v34, s39
    v_perm_b32 v51, v46, v42, s39
    s_nop 1
    v_mfma_f32_16x16x16_bf16 v[84:87], v[10:11], v[50:51], 0
    v_perm_b32 v52, v39, v35, s38
    v_perm_b32 v53, v47, v43, s38
    s_nop 1
    v_mfma_f32_16x16x16_bf16 v[88:91], v[10:11], v[52:53], 0
    v_perm_b32 v54, v39, v35, s39
    v_perm_b32 v55, v47, v43, s39
    s_nop 1
    v_mfma_f32_16x16x16_bf16 v[92:95], v[10:11], v[54:55], 0
    s_mov_b32 exec_lo, 0xffffffff
    s_mov_b32 exec_hi, 0x0
    ds_write2_b32 v4, v64, v68 offset0:0 offset1:1
    ds_write2_b32 v4, v72, v76 offset0:2 offset1:3
    ds_write2_b32 v4, v80, v84 offset0:4 offset1:5
    s_nop 2
    ds_write2_b32 v4, v88, v92 offset0:6 offset1:7
    s_mov_b64 exec, -1
    s_waitcnt lgkmcnt(0)
    s_barrier
    s_cmp_eq_u32 s3, 7
    s_cbranch_scc0 L_skip_130
    v_lshlrev_b32 v4, 4, v0
    ds_read_b128 v[64:67], v4 offset:16384
    ds_read_b128 v[68:71], v4 offset:17408
    ds_read_b128 v[72:75], v4 offset:18432
    ds_read_b128 v[76:79], v4 offset:19456
    ds_read_b128 v[80:83], v4 offset:20480
    ds_read_b128 v[84:87], v4 offset:21504
    ds_read_b128 v[88:91], v4 offset:22528
    ds_read_b128 v[92:95], v4 offset:23552
    s_lshl_b32 s62, s101, 10
    s_add_u32 s42, s30, s62
    s_addc_u32 s43, s31, 0
    s_add_u32 s42, s42, 65536
    s_addc_u32 s43, s43, 0
    s_waitcnt lgkmcnt(0)
    v_add_f32 v64, v64, v80
    v_add_f32 v65, v65, v81
    v_add_f32 v66, v66, v82
    v_add_f32 v67, v67, v83
    v_add_f32 v68, v68, v84
    v_add_f32 v69, v69, v85
    v_add_f32 v70, v70, v86
    v_add_f32 v71, v71, v87
    v_add_f32 v72, v72, v88
    v_add_f32 v73, v73, v89
    v_add_f32 v74, v74, v90
    v_add_f32 v75, v75, v91
    v_add_f32 v76, v76, v92
    v_add_f32 v77, v77, v93
    v_add_f32 v78, v78, v94
    v_add_f32 v79, v79, v95
    v_add_f32 v64, v64, v72
    v_add_f32 v65, v65, v73
    v_add_f32 v66, v66, v74
    v_add_f32 v67, v67, v75
    v_add_f32 v68, v68, v76
    v_add_f32 v69, v69, v77
    v_add_f32 v70, v70, v78
    v_add_f32 v71, v71, v79
    v_add_f32 v64, v64, v68
    v_add_f32 v65, v65, v69
    v_add_f32 v66, v66, v70
    v_add_f32 v67, v67, v71
    v_perm_b32 v64, v64, v3, s34
    v_perm_b32 v65, v65, v3, s35
    v_perm_b32 v66, v66, v3, s36
    v_perm_b32 v67, v67, v3, s37
    s_cmp_lg_u32 s90, 0
    s_cbranch_scc1 L_sl_131
    global_store_dwordx4 v4, v[64:67], s[42:43] sc1
    s_branch L_sd_132
L_sl_131:
    global_store_dwordx4 v4, v[64:67], s[42:43]
L_sd_132:
L_skip_130:
    s_and_b32 s62, s2, 31
    s_lshl_b32 s62, s62, 17
    s_lshr_b32 s63, s3, 2
    s_lshl_b32 s63, s63, 16
    s_add_u32 s62, s62, s63
    s_and_b32 s63, s3, 3
    s_lshl_b32 s63, s63, 8
    s_add_u32 s62, s62, s63
    s_add_u32 s98, s24, s62
    s_addc_u32 s99, s25, 0
    v_lshlrev_b32 v144, 13, v2
    v_lshl_add_u32 v144, v1, 4, v144
    s_and_b32 s62, s3, 3
    s_lshl_b32 s62, s62, 15
    s_lshr_b32 s63, s3, 2
    s_lshl_b32 s63, s63, 14
    s_add_u32 s62, s62, s63
    s_add_u32 s62, s62, 32768
    v_add_u32 v145, s62, v97
    s_and_b32 s62, s53, 7
    s_lshl_b32 s62, s62, 14
    s_lshr_b32 s63, s3, 1
    s_lshl_b32 s63, s63, 12
    s_add_u32 s62, s62, s63
    s_lshr_b32 s63, s53, 3
    s_lshl_b32 s63, s63, 9
    s_add_u32 s62, s62, s63
    s_and_b32 s63, s3, 1
    s_lshl_b32 s63, s63, 8
    s_add_u32 s62, s62, s63
    s_add_u32 s40, s30, s62
    s_addc_u32 s41, s31, 0
    s_add_u32 s40, s40, 196608
    s_addc_u32 s41, s41, 0
    s_waitcnt vmcnt(4)
    global_load_dwordx4 v[168:171], v96, s[44:45] offset:128 nt
    s_waitcnt vmcnt(4)
    global_load_dwordx4 v[164:167], v96, s[44:45] offset:1024 nt
    s_waitcnt vmcnt(4)
    global_load_dwordx4 v[172:175], v96, s[44:45] offset:1152 nt
    s_add_u32 s44, s44, 4096
    s_addc_u32 s45, s45, 0
    s_waitcnt vmcnt(4)
    global_load_dwordx4 v[176:179], v96, s[44:45] offset:0 nt
    s_waitcnt vmcnt(4)
    global_load_dwordx4 v[184:187], v96, s[44:45] offset:128 nt
    s_waitcnt vmcnt(4)
    global_load_dwordx4 v[180:183], v96, s[44:45] offset:1024 nt
    s_waitcnt vmcnt(4)
    global_load_dwordx4 v[188:191], v96, s[44:45] offset:1152 nt
    s_add_u32 s44, s44, 4096
    s_addc_u32 s45, s45, 0
    s_cmp_ge_u32 s3, 6
    s_cbranch_scc0 L_skip_133
    s_and_b32 s62, s53, 7
    s_lshl_b32 s62, s62, 7
    s_add_u32 s60, s30, s62
    s_addc_u32 s61, s31, 0
    s_add_u32 s60, s60, 638976
    s_addc_u32 s61, s61, 0
    v_and_b32 v12, 31, v0
    v_lshlrev_b32 v12, 2, v12
    global_load_dword v12, v12, s[60:61] sc1
L_skip_133:
    global_load_dwordx4 v[8:11], v98, s[40:41] offset:0 sc1
    s_waitcnt vmcnt(4)
    global_load_dwordx4 v[192:195], v96, s[44:45] offset:0 nt
    s_waitcnt vmcnt(4)
    global_load_dwordx4 v[200:203], v96, s[44:45] offset:128 nt
    s_waitcnt vmcnt(4)
    global_load_dwordx4 v[196:199], v96, s[44:45] offset:1024 nt
    s_waitcnt vmcnt(4)
    global_load_dwordx4 v[204:207], v96, s[44:45] offset:1152 nt
    s_add_u32 s44, s44, 4096
    s_addc_u32 s45, s45, 0
    s_cmp_lt_u32 s3, s56
    s_cbranch_scc0 L_skip_134
    s_waitcnt vmcnt(4)
    global_load_dwordx4 v[208:211], v96, s[44:45] offset:0 nt
    s_waitcnt vmcnt(4)
    global_load_dwordx4 v[216:219], v96, s[44:45] offset:128 nt
    s_waitcnt vmcnt(4)
    global_load_dwordx4 v[212:215], v96, s[44:45] offset:1024 nt
    s_waitcnt vmcnt(4)
    global_load_dwordx4 v[220:223], v96, s[44:45] offset:1152 nt
    s_add_u32 s44, s44, 4096
    s_addc_u32 s45, s45, 0
L_skip_134:
    s_waitcnt vmcnt(4)
    global_load_dwordx4 v[16:19], v97, s[46:47] offset:0 nt
    s_waitcnt vmcnt(4)
    global_load_dwordx4 v[20:23], v97, s[46:47] offset:1024 nt
    s_waitcnt vmcnt(4)
    global_load_dwordx4 v[24:27], v97, s[46:47] offset:2048 nt
    s_waitcnt vmcnt(4)
    global_load_dwordx4 v[28:31], v97, s[46:47] offset:3072 nt
    s_add_u32 s46, s46, 4096
    s_addc_u32 s47, s47, 0
    s_mov_b32 s52, 2097152
    s_waitcnt vmcnt(8)
    v_perm_b32 v5, v11, v8, s48
    v_cmp_ne_u32 s[60:61], s49, v5
    s_nop 0
    s_cmp_eq_u64 s[60:61], 0
    s_cbranch_scc1 L_got_136
L_poll_135:
    s_sub_u32 s52, s52, 1
    s_cbranch_scc1 L_got_136
    global_load_dwordx4 v[8:11], v98, s[40:41] offset:0 sc1
    s_waitcnt vmcnt(0)
    v_perm_b32 v5, v11, v8, s48
    v_cmp_ne_u32 s[60:61], s49, v5
    s_nop 0
    s_cmp_eq_u64 s[60:61], 0
    s_cbranch_scc0 L_poll_135
L_got_136:
    s_cmp_ge_u32 s3, 6
    s_cbranch_scc0 L_skip_137
    v_cmp_ne_u32 s[60:61], s33, v12
    s_nop 0
    s_cmp_eq_u64 s[60:61], 0
    s_cselect_b32 s90, 1, 0
L_skip_137:
    v_and_b32 v8, s50, v8
    v_and_b32 v9, s50, v9
    v_and_b32 v10, s50, v10
    v_and_b32 v11, s50, v11
    v_mov_b32 v48, v8
    v_mov_b32 v49, v9
    v_mov_b32 v50, v10
    v_mov_b32 v51, v11
    v_permlane16_swap_b32 v48, v8
    v_permlane16_swap_b32 v49, v9
    v_permlane16_swap_b32 v50, v10
    v_permlane16_swap_b32 v51, v11
    v_add_f32 v8, v8, v48
    v_add_f32 v9, v9, v49
    v_add_f32 v10, v10, v50
    v_add_f32 v11, v11, v51
    v_mov_b32 v48, v8
    v_mov_b32 v49, v9
    v_mov_b32 v50, v10
    v_mov_b32 v51, v11
    v_permlane32_swap_b32 v48, v8
    v_permlane32_swap_b32 v49, v9
    v_permlane32_swap_b32 v50, v10
    v_permlane32_swap_b32 v51, v11
    v_add_f32 v8, v8, v48
    v_add_f32 v9, v9, v49
    v_add_f32 v10, v10, v50
    v_add_f32 v11, v11, v51
    v_cvt_pk_bf16_f32 v8, v8, v9
    v_cvt_pk_bf16_f32 v9, v10, v11
    s_lshl_b32 s62, s3, 7
    v_lshlrev_b32 v4, 3, v1
    v_add_u32 v4, s62, v4
    s_mov_b32 exec_lo, 0xffff
    s_mov_b32 exec_hi, 0x0
    ds_write_b64 v4, v[8:9] offset:8192
    v_mov_b32 v6, 1
    v_mov_b32 v7, 9728
    s_mov_b32 exec_lo, 0x1
    s_mov_b32 exec_hi, 0x0
    ds_add_u32 v7, v6
    s_mov_b64 exec, -1
    s_waitcnt vmcnt(4)
    global_load_dwordx4 v[32:35], v97, s[46:47] offset:0 nt
    s_waitcnt vmcnt(4)
    global_load_dwordx4 v[36:39], v97, s[46:47] offset:1024 nt
    s_waitcnt vmcnt(4)
    global_load_dwordx4 v[40:43], v97, s[46:47] offset:2048 nt
    s_waitcnt vmcnt(4)
    global_load_dwordx4 v[44:47], v97, s[46:47] offset:3072 nt
    s_add_u32 s46, s46, 4096
    s_addc_u32 s47, s47, 0
    v_mov_b32 v7, 9728
    s_mov_b32 s52, 33554432
L_cnt_138:
    ds_read_b32 v6, v7
    s_sub_u32 s52, s52, 1
    s_cbranch_scc1 L_cntok_139
    s_waitcnt lgkmcnt(0)
    v_readfirstlane_b32 s62, v6
    s_nop 0
    s_cmp_lt_u32 s62, 8
    s_cbranch_scc1 L_cnt_138
L_cntok_139:
    v_lshrrev_b32 v4, 2, v1
    v_lshlrev_b32 v4, 8, v4
    v_lshl_add_u32 v4, v2, 5, v4
    ds_read_b128 v[128:131], v4 offset:8192
    ds_read_b128 v[132:135], v4 offset:8208
    ds_read_b128 v[136:139], v4 offset:8320
    ds_read_b128 v[140:143], v4 offset:8336
    v_mov_b32 v112, 0xff800000
    v_mov_b32 v113, 0xff800000
    v_mov_b32 v114, 0xff800000
    v_mov_b32 v115, 0xff800000
    s_waitcnt lgkmcnt(0)
    s_waitcnt vmcnt(17)
    s_mov_b64 vcc, s[96:97]
    v_cndmask_b32_dpp v48, v164, v160, vcc quad_perm:[1,0,3,2] row_mask:0xf bank_mask:0xf
    v_xor_b32 v160, v160, v48
    v_cndmask_b32_dpp v49, v165, v161, vcc quad_perm:[1,0,3,2] row_mask:0xf bank_mask:0xf
    v_xor_b32 v161, v161, v49
    v_cndmask_b32_dpp v50, v166, v162, vcc quad_perm:[1,0,3,2] row_mask:0xf bank_mask:0xf
    v_xor_b32 v162, v162, v50
    v_cndmask_b32_dpp v51, v167, v163, vcc quad_perm:[1,0,3,2] row_mask:0xf bank_mask:0xf
    v_xor_b32 v163, v163, v51
    v_xor_b32_dpp v164, v160, v164 quad_perm:[1,0,3,2] row_mask:0xf bank_mask:0xf
    v_xor_b32_dpp v165, v161, v165 quad_perm:[1,0,3,2] row_mask:0xf bank_mask:0xf
    v_xor_b32_dpp v166, v162, v166 quad_perm:[1,0,3,2] row_mask:0xf bank_mask:0xf
    v_xor_b32_dpp v167, v163, v167 quad_perm:[1,0,3,2] row_mask:0xf bank_mask:0xf
    v_cndmask_b32_dpp v52, v172, v168, vcc quad_perm:[1,0,3,2] row_mask:0xf bank_mask:0xf
    v_xor_b32 v168, v168, v52
    v_cndmask_b32_dpp v53, v173, v169, vcc quad_perm:[1,0,3,2] row_mask:0xf bank_mask:0xf
    v_xor_b32 v169, v169, v53
    v_cndmask_b32_dpp v54, v174, v170, vcc quad_perm:[1,0,3,2] row_mask:0xf bank_mask:0xf
    v_xor_b32 v170, v170, v54
    v_cndmask_b32_dpp v55, v175, v171, vcc quad_perm:[1,0,3,2] row_mask:0xf bank_mask:0xf
    v_xor_b32 v171, v171, v55
    v_xor_b32_dpp v172, v168, v172 quad_perm:[1,0,3,2] row_mask:0xf bank_mask:0xf
    v_xor_b32_dpp v173, v169, v173 quad_perm:[1,0,3,2] row_mask:0xf bank_mask:0xf
    v_xor_b32_dpp v174, v170, v174 quad_perm:[1,0,3,2] row_mask:0xf bank_mask:0xf
    v_xor_b32_dpp v175, v171, v175 quad_perm:[1,0,3,2] row_mask:0xf bank_mask:0xf
    v_mfma_f32_16x16x32_bf16 v[100:103], v[48:51], v[128:131], 0
    v_mfma_f32_16x16x32_bf16 v[100:103], v[164:167], v[132:135], v[100:103]
    v_mfma_f32_16x16x32_bf16 v[100:103], v[52:55], v[136:139], v[100:103]
    v_mfma_f32_16x16x32_bf16 v[100:103], v[172:175], v[140:143], v[100:103]
    s_waitcnt vmcnt(13)
    s_mov_b64 vcc, s[96:97]
    v_cndmask_b32_dpp v56, v180, v176, vcc quad_perm:[1,0,3,2] row_mask:0xf bank_mask:0xf
    v_xor_b32 v176, v176, v56
    v_cndmask_b32_dpp v57, v181, v177, vcc quad_perm:[1,0,3,2] row_mask:0xf bank_mask:0xf
    v_xor_b32 v177, v177, v57
    v_cndmask_b32_dpp v58, v182, v178, vcc quad_perm:[1,0,3,2] row_mask:0xf bank_mask:0xf
    v_xor_b32 v178, v178, v58
    v_cndmask_b32_dpp v59, v183, v179, vcc quad_perm:[1,0,3,2] row_mask:0xf bank_mask:0xf
    v_xor_b32 v179, v179, v59
    v_xor_b32_dpp v180, v176, v180 quad_perm:[1,0,3,2] row_mask:0xf bank_mask:0xf
    v_xor_b32_dpp v181, v177, v181 quad_perm:[1,0,3,2] row_mask:0xf bank_mask:0xf
    v_xor_b32_dpp v182, v178, v182 quad_perm:[1,0,3,2] row_mask:0xf bank_mask:0xf
    v_xor_b32_dpp v183, v179, v183 quad_perm:[1,0,3,2] row_mask:0xf bank_mask:0xf
    v_cndmask_b32_dpp v60, v188, v184, vcc quad_perm:[1,0,3,2] row_mask:0xf bank_mask:0xf
    v_xor_b32 v184, v184, v60
    v_cndmask_b32_dpp v61, v189, v185, vcc quad_perm:[1,0,3,2] row_mask:0xf bank_mask:0xf
    v_xor_b32 v185, v185, v61
    v_cndmask_b32_dpp v62, v190, v186, vcc quad_perm:[1,0,3,2] row_mask:0xf bank_mask:0xf
    v_xor_b32 v186, v186, v62
    v_cndmask_b32_dpp v63, v191, v187, vcc quad_perm:[1,0,3,2] row_mask:0xf bank_mask:0xf
    v_xor_b32 v187, v187, v63
    v_xor_b32_dpp v188, v184, v188 quad_perm:[1,0,3,2] row_mask:0xf bank_mask:0xf
    v_xor_b32_dpp v189, v185, v189 quad_perm:[1,0,3,2] row_mask:0xf bank_mask:0xf
    v_xor_b32_dpp v190, v186, v190 quad_perm:[1,0,3,2] row_mask:0xf bank_mask:0xf
    v_xor_b32_dpp v191, v187, v191 quad_perm:[1,0,3,2] row_mask:0xf bank_mask:0xf
    v_mfma_f32_16x16x32_bf16 v[104:107], v[56:59], v[128:131], 0
    v_mfma_f32_16x16x32_bf16 v[104:107], v[180:183], v[132:135], v[104:107]
    v_mfma_f32_16x16x32_bf16 v[104:107], v[60:63], v[136:139], v[104:107]
    v_mfma_f32_16x16x32_bf16 v[104:107], v[188:191], v[140:143], v[104:107]
    s_waitcnt vmcnt(8)
    s_mov_b64 vcc, s[96:97]
    v_cndmask_b32_dpp v48, v196, v192, vcc quad_perm:[1,0,3,2] row_mask:0xf bank_mask:0xf
    v_xor_b32 v192, v192, v48
    v_cndmask_b32_dpp v49, v197, v193, vcc quad_perm:[1,0,3,2] row_mask:0xf bank_mask:0xf
    v_xor_b32 v193, v193, v49
    v_cndmask_b32_dpp v50, v198, v194, vcc quad_perm:[1,0,3,2] row_mask:0xf bank_mask:0xf
    v_xor_b32 v194, v194, v50
    v_cndmask_b32_dpp v51, v199, v195, vcc quad_perm:[1,0,3,2] row_mask:0xf bank_mask:0xf
    v_xor_b32 v195, v195, v51
    v_xor_b32_dpp v196, v192, v196 quad_perm:[1,0,3,2] row_mask:0xf bank_mask:0xf
    v_xor_b32_dpp v197, v193, v197 quad_perm:[1,0,3,2] row_mask:0xf bank_mask:0xf
    v_xor_b32_dpp v198, v194, v198 quad_perm:[1,0,3,2] row_mask:0xf bank_mask:0xf
    v_xor_b32_dpp v199, v195, v199 quad_perm:[1,0,3,2] row_mask:0xf bank_mask:0xf
    v_cndmask_b32_dpp v52, v204, v200, vcc quad_perm:[1,0,3,2] row_mask:0xf bank_mask:0xf
    v_xor_b32 v200, v200, v52
    v_cndmask_b32_dpp v53, v205, v201, vcc quad_perm:[1,0,3,2] row_mask:0xf bank_mask:0xf
    v_xor_b32 v201, v201, v53
    v_cndmask_b32_dpp v54, v206, v202, vcc quad_perm:[1,0,3,2] row_mask:0xf bank_mask:0xf
    v_xor_b32 v202, v202, v54
    v_cndmask_b32_dpp v55, v207, v203, vcc quad_perm:[1,0,3,2] row_mask:0xf bank_mask:0xf
    v_xor_b32 v203, v203, v55
    v_xor_b32_dpp v204, v200, v204 quad_perm:[1,0,3,2] row_mask:0xf bank_mask:0xf
    v_xor_b32_dpp v205, v201, v205 quad_perm:[1,0,3,2] row_mask:0xf bank_mask:0xf
    v_xor_b32_dpp v206, v202, v206 quad_perm:[1,0,3,2] row_mask:0xf bank_mask:0xf
    v_xor_b32_dpp v207, v203, v207 quad_perm:[1,0,3,2] row_mask:0xf bank_mask:0xf
    v_mfma_f32_16x16x32_bf16 v[108:111], v[48:51], v[128:131], 0
    v_mfma_f32_16x16x32_bf16 v[108:111], v[196:199], v[132:135], v[108:111]
    v_mfma_f32_16x16x32_bf16 v[108:111], v[52:55], v[136:139], v[108:111]
    v_mfma_f32_16x16x32_bf16 v[108:111], v[204:207], v[140:143], v[108:111]
    s_cmp_lt_u32 s3, s56
    s_cbranch_scc0 L_skip_140
    s_waitcnt vmcnt(8)
    s_mov_b64 vcc, s[96:97]
    v_cndmask_b32_dpp v56, v212, v208, vcc quad_perm:[1,0,3,2] row_mask:0xf bank_mask:0xf
    v_xor_b32 v208, v208, v56
    v_cndmask_b32_dpp v57, v213, v209, vcc quad_perm:[1,0,3,2] row_mask:0xf bank_mask:0xf
    v_xor_b32 v209, v209, v57
    v_cndmask_b32_dpp v58, v214, v210, vcc quad_perm:[1,0,3,2] row_mask:0xf bank_mask:0xf
    v_xor_b32 v210, v210, v58
    v_cndmask_b32_dpp v59, v215, v211, vcc quad_perm:[1,0,3,2] row_mask:0xf bank_mask:0xf
    v_xor_b32 v211, v211, v59
    v_xor_b32_dpp v212, v208, v212 quad_perm:[1,0,3,2] row_mask:0xf bank_mask:0xf
    v_xor_b32_dpp v213, v209, v213 quad_perm:[1,0,3,2] row_mask:0xf bank_mask:0xf
    v_xor_b32_dpp v214, v210, v214 quad_perm:[1,0,3,2] row_mask:0xf bank_mask:0xf
    v_xor_b32_dpp v215, v211, v215 quad_perm:[1,0,3,2] row_mask:0xf bank_mask:0xf
    v_cndmask_b32_dpp v60, v220, v216, vcc quad_perm:[1,0,3,2] row_mask:0xf bank_mask:0xf
    v_xor_b32 v216, v216, v60
    v_cndmask_b32_dpp v61, v221, v217, vcc quad_perm:[1,0,3,2] row_mask:0xf bank_mask:0xf
    v_xor_b32 v217, v217, v61
    v_cndmask_b32_dpp v62, v222, v218, vcc quad_perm:[1,0,3,2] row_mask:0xf bank_mask:0xf
    v_xor_b32 v218, v218, v62
    v_cndmask_b32_dpp v63, v223, v219, vcc quad_perm:[1,0,3,2] row_mask:0xf bank_mask:0xf
    v_xor_b32 v219, v219, v63
    v_xor_b32_dpp v220, v216, v220 quad_perm:[1,0,3,2] row_mask:0xf bank_mask:0xf
    v_xor_b32_dpp v221, v217, v221 quad_perm:[1,0,3,2] row_mask:0xf bank_mask:0xf
    v_xor_b32_dpp v222, v218, v222 quad_perm:[1,0,3,2] row_mask:0xf bank_mask:0xf
    v_xor_b32_dpp v223, v219, v223 quad_perm:[1,0,3,2] row_mask:0xf bank_mask:0xf
    v_mfma_f32_16x16x32_bf16 v[112:115], v[56:59], v[128:131], 0
    v_mfma_f32_16x16x32_bf16 v[112:115], v[212:215], v[132:135], v[112:115]
    v_mfma_f32_16x16x32_bf16 v[112:115], v[60:63], v[136:139], v[112:115]
    v_mfma_f32_16x16x32_bf16 v[112:115], v[220:223], v[140:143], v[112:115]
L_skip_140:
    s_waitcnt vmcnt(4)
    global_load_dwordx4 v[160:163], v97, s[46:47] offset:0 nt
    s_waitcnt vmcnt(4)
    global_load_dwordx4 v[164:167], v97, s[46:47] offset:1024 nt
    s_waitcnt vmcnt(4)
    global_load_dwordx4 v[168:171], v97, s[46:47] offset:2048 nt
    s_waitcnt vmcnt(4)
    global_load_dwordx4 v[172:175], v97, s[46:47] offset:3072 nt
    s_add_u32 s46, s46, 4096
    s_addc_u32 s47, s47, 0
    s_cmp_lt_u32 s3, s56
    s_cbranch_scc0 L_skip_141
    s_waitcnt vmcnt(4)
    global_load_dwordx4 v[176:179], v97, s[46:47] offset:0 nt
    s_waitcnt vmcnt(4)
    global_load_dwordx4 v[180:183], v97, s[46:47] offset:1024 nt
    s_waitcnt vmcnt(4)
    global_load_dwordx4 v[184:187], v97, s[46:47] offset:2048 nt
    s_waitcnt vmcnt(4)
    global_load_dwordx4 v[188:191], v97, s[46:47] offset:3072 nt
    s_add_u32 s46, s46, 4096
    s_addc_u32 s47, s47, 0
L_skip_141:
    v_max3_f32 v4, v100, v101, v102
    v_max3_f32 v4, v4, v103, v104
    v_max3_f32 v4, v4, v105, v106
    v_max3_f32 v4, v4, v107, v108
    v_max3_f32 v4, v4, v109, v110
    v_max3_f32 v4, v4, v111, v112
    v_max3_f32 v4, v4, v113, v114
    v_max_f32 v4, v4, v115
    v_mov_b32 v5, v4
    s_nop 1
    v_permlane16_swap_b32 v5, v4
    v_max_f32 v4, v4, v5
    v_mov_b32 v5, v4
    s_nop 1
    v_permlane32_swap_b32 v5, v4
    v_max_f32 v4, v4, v5
    v_mul_f32 v4, s51, v4
    v_fma_f32 v100, v100, s51, -v4
    v_fma_f32 v101, v101, s51, -v4
    v_fma_f32 v102, v102, s51, -v4
    v_fma_f32 v103, v103, s51, -v4
    v_fma_f32 v104, v104, s51, -v4
    v_fma_f32 v105, v105, s51, -v4
    v_fma_f32 v106, v106, s51, -v4
    v_fma_f32 v107, v107, s51, -v4
    v_fma_f32 v108, v108, s51, -v4
    v_fma_f32 v109, v109, s51, -v4
    v_fma_f32 v110, v110, s51, -v4
    v_fma_f32 v111, v111, s51, -v4
    v_fma_f32 v112, v112, s51, -v4
    v_fma_f32 v113, v113, s51, -v4
    v_fma_f32 v114, v114, s51, -v4
    v_fma_f32 v115, v115, s51, -v4
    v_exp_f32 v100, v100
    v_exp_f32 v101, v101
    v_exp_f32 v102, v102
    v_exp_f32 v103, v103
    v_exp_f32 v104, v104
    v_exp_f32 v105, v105
    v_exp_f32 v106, v106
    v_exp_f32 v107, v107
    v_exp_f32 v108, v108
    v_exp_f32 v109, v109
    v_exp_f32 v110, v110
    v_exp_f32 v111, v111
    v_exp_f32 v112, v112
    v_exp_f32 v113, v113
    v_exp_f32 v114, v114
    v_exp_f32 v115, v115
    v_add_f32 v5, v100, v101
    v_add_f32 v5, v5, v102
    v_add_f32 v5, v5, v103
    v_add_f32 v5, v5, v104
    v_add_f32 v5, v5, v105
    v_add_f32 v5, v5, v106
    v_add_f32 v5, v5, v107
    v_add_f32 v5, v5, v108
    v_add_f32 v5, v5, v109
    v_add_f32 v5, v5, v110
    v_add_f32 v5, v5, v111
    v_add_f32 v5, v5, v112
    v_add_f32 v5, v5, v113
    v_add_f32 v5, v5, v114
    v_add_f32 v5, v5, v115
    v_cvt_pk_bf16_f32 v100, v100, v101
    v_cvt_pk_bf16_f32 v101, v102, v103
    v_cvt_pk_bf16_f32 v102, v104, v105
    v_cvt_pk_bf16_f32 v103, v106, v107
    v_cvt_pk_bf16_f32 v104, v108, v109
    v_cvt_pk_bf16_f32 v105, v110, v111
    v_cvt_pk_bf16_f32 v106, v112, v113
    v_cvt_pk_bf16_f32 v107, v114, v115
    v_mov_b32 v6, v5
    s_nop 1
    v_permlane16_swap_b32 v6, v5
    v_add_f32 v5, v5, v6
    v_mov_b32 v6, v5
    s_nop 1
    v_permlane32_swap_b32 v6, v5
    v_add_f32 v5, v5, v6
    s_lshl_b32 s62, s3, 5
    v_lshlrev_b32 v6, 1, v1
    v_add_u32 v6, s62, v6
    s_mov_b32 exec_lo, 0x1111
    s_mov_b32 exec_hi, 0x0
    ds_write_b64 v6, v[4:5] offset:9216
    v_mov_b32 v6, 1
    v_mov_b32 v7, 9732
    s_mov_b32 exec_lo, 0x1
    s_mov_b32 exec_hi, 0x0
    ds_add_u32 v7, v6
    s_mov_b64 exec, -1
    s_waitcnt vmcnt(4)
    v_perm_b32 v48, v20, v16, s38
    v_perm_b32 v49, v28, v24, s38
    v_perm_b32 v50, v36, v32, s38
    v_perm_b32 v51, v44, v40, s38
    s_nop 1
    v_mfma_f32_16x16x32_bf16 v[64:67], v[100:103], v[48:51], 0
    v_perm_b32 v52, v20, v16, s39
    v_perm_b32 v53, v28, v24, s39
    v_perm_b32 v54, v36, v32, s39
    v_perm_b32 v55, v44, v40, s39
    s_nop 1
    v_mfma_f32_16x16x32_bf16 v[68:71], v[100:103], v[52:55], 0
    v_perm_b32 v56, v21, v17, s38
    v_perm_b32 v57, v29, v25, s38
    v_perm_b32 v58, v37, v33, s38
    v_perm_b32 v59, v45, v41, s38
    s_nop 1
    v_mfma_f32_16x16x32_bf16 v[72:75], v[100:103], v[56:59], 0
    v_perm_b32 v60, v21, v17, s39
    v_perm_b32 v61, v29, v25, s39
    v_perm_b32 v62, v37, v33, s39
    v_perm_b32 v63, v45, v41, s39
    s_nop 1
    v_mfma_f32_16x16x32_bf16 v[76:79], v[100:103], v[60:63], 0
    v_perm_b32 v48, v22, v18, s38
    v_perm_b32 v49, v30, v26, s38
    v_perm_b32 v50, v38, v34, s38
    v_perm_b32 v51, v46, v42, s38
    s_nop 1
    v_mfma_f32_16x16x32_bf16 v[80:83], v[100:103], v[48:51], 0
    v_perm_b32 v52, v22, v18, s39
    v_perm_b32 v53, v30, v26, s39
    v_perm_b32 v54, v38, v34, s39
    v_perm_b32 v55, v46, v42, s39
    s_nop 1
    v_mfma_f32_16x16x32_bf16 v[84:87], v[100:103], v[52:55], 0
    v_perm_b32 v56, v23, v19, s38
    v_perm_b32 v57, v31, v27, s38
    v_perm_b32 v58, v39, v35, s38
    v_perm_b32 v59, v47, v43, s38
    s_nop 1
    v_mfma_f32_16x16x32_bf16 v[88:91], v[100:103], v[56:59], 0
    v_perm_b32 v60, v23, v19, s39
    v_perm_b32 v61, v31, v27, s39
    v_perm_b32 v62, v39, v35, s39
    v_perm_b32 v63, v47, v43, s39
    s_nop 1
    v_mfma_f32_16x16x32_bf16 v[92:95], v[100:103], v[60:63], 0
    v_mov_b32 v7, 9732
    s_mov_b32 s52, 33554432
L_cnt_142:
    ds_read_b32 v6, v7
    s_sub_u32 s52, s52, 1
    s_cbranch_scc1 L_cntok_143
    s_waitcnt lgkmcnt(0)
    v_readfirstlane_b32 s62, v6
    s_nop 0
    s_cmp_lt_u32 s62, 8
    s_cbranch_scc1 L_cnt_142
L_cntok_143:
    v_lshlrev_b32 v6, 3, v2
    ds_read_b64 v[16:17], v6 offset:9216
    ds_read_b64 v[18:19], v6 offset:9248
    ds_read_b64 v[20:21], v6 offset:9280
    ds_read_b64 v[22:23], v6 offset:9312
    ds_read_b64 v[24:25], v6 offset:9344
    ds_read_b64 v[26:27], v6 offset:9376
    ds_read_b64 v[28:29], v6 offset:9408
    ds_read_b64 v[30:31], v6 offset:9440
    s_lshl_b32 s62, s3, 5
    v_add_u32 v6, s62, v6
    ds_read_b64 v[4:5], v6 offset:9216
    s_waitcnt lgkmcnt(0)
    v_max3_f32 v7, v16, v18, v20
    v_max3_f32 v7, v7, v22, v24
    v_max3_f32 v7, v7, v26, v28
    v_max_f32 v7, v7, v30
    v_sub_f32 v16, v16, v7
    v_sub_f32 v18, v18, v7
    v_sub_f32 v20, v20, v7
    v_sub_f32 v22, v22, v7
    v_sub_f32 v24, v24, v7
    v_sub_f32 v26, v26, v7
    v_sub_f32 v28, v28, v7
    v_sub_f32 v30, v30, v7
    v_sub_f32 v4, v4, v7
    v_exp_f32 v16, v16
    v_exp_f32 v18, v18
    v_exp_f32 v20, v20
    v_exp_f32 v22, v22
    v_exp_f32 v24, v24
    v_exp_f32 v26, v26
    v_exp_f32 v28, v28
    v_exp_f32 v30, v30
    v_exp_f32 v4, v4
    v_mul_f32 v5, v16, v17
    v_fmac_f32 v5, v18, v19
    v_fmac_f32 v5, v20, v21
    v_fmac_f32 v5, v22, v23
    v_fmac_f32 v5, v24, v25
    v_fmac_f32 v5, v26, v27
    v_fmac_f32 v5, v28, v29
    v_fmac_f32 v5, v30, v31
    v_rcp_f32 v6, v5
    v_log_f32 v5, v5
    v_mul_f32 v99, v4, v6
    s_cmp_eq_u32 s3, 7
    s_cbranch_scc0 L_skip_144
    v_add_f32 v8, v5, v7
    v_add_f32 v9, v5, v7
    v_add_f32 v10, v5, v7
    v_add_f32 v11, v5, v7
    v_perm_b32 v8, v8, v3, s34
    v_perm_b32 v9, v9, v3, s35
    v_perm_b32 v10, v10, v3, s36
    v_perm_b32 v11, v11, v3, s37
    s_and_b32 s62, s53, 7
    s_lshl_b32 s62, s62, 11
    s_lshr_b32 s63, s53, 3
    s_lshl_b32 s63, s63, 8
    s_add_u32 s62, s62, s63
    s_lshl_b32 s63, s54, 4
    s_add_u32 s62, s62, s63
    s_add_u32 s40, s30, s62
    s_addc_u32 s41, s31, 0
    s_add_u32 s40, s40, 655360
    s_addc_u32 s41, s41, 0
    v_lshlrev_b32 v4, 9, v2
    s_mov_b32 exec_lo, 0x10001
    s_mov_b32 exec_hi, 0x10001
    s_cmp_lg_u32 s90, 0
    s_cbranch_scc1 L_sl_145
    global_store_dwordx4 v4, v[8:11], s[40:41] sc1
    s_branch L_sd_146
L_sl_145:
    global_store_dwordx4 v4, v[8:11], s[40:41]
L_sd_146:
    s_mov_b64 exec, -1
L_skip_144:
    s_and_b32 s62, s53, 7
    s_lshl_b32 s62, s62, 3
    s_and_b32 s63, s3, 1
    s_lshl_b32 s63, s63, 2
    s_add_u32 s62, s62, s63
    s_lshr_b32 s63, s53, 3
    s_add_u32 s62, s62, s63
    s_mul_i32 s62, s62, 16
    s_add_u32 s62, s62, s54
    s_lshl_b32 s62, s62, 9
    s_add_u32 s40, s30, s62
    s_addc_u32 s41, s31, 0
    s_add_u32 s40, s40, 720896
    s_addc_u32 s41, s41, 0
    v_lshrrev_b32 v4, 5, v0
    v_mul_u32_u24 v4, 16384, v4
    v_and_b32 v5, 31, v0
    v_lshl_add_u32 v98, v5, 4, v4
    s_lshl_b32 s62, s3, 11
    v_lshlrev_b32 v4, 9, v2
    v_lshl_add_u32 v4, v1, 5, v4
    v_add_u32 v96, s62, v4
    s_and_b32 s62, s3, 1
    s_lshl_b32 s62, s62, 10
    v_add_u32 v16, s62, v97
    s_waitcnt vmcnt(4)
    global_load_dwordx4 v[224:227], v144, s[98:99] offset:0 nt
    s_waitcnt vmcnt(4)
    global_load_dwordx4 v[228:231], v144, s[98:99] offset:1024 nt
    s_waitcnt vmcnt(4)
    global_load_dwordx4 v[232:235], v144, s[98:99] offset:2048 nt
    s_waitcnt vmcnt(4)
    global_load_dwordx4 v[236:239], v144, s[98:99] offset:3072 nt
    s_add_u32 s98, s98, 4096
    s_addc_u32 s99, s99, 0
    s_waitcnt vmcnt(4)
    global_load_dwordx4 v[240:243], v144, s[98:99] offset:0 nt
    s_waitcnt vmcnt(4)
    global_load_dwordx4 v[244:247], v144, s[98:99] offset:1024 nt
    s_waitcnt vmcnt(4)
    global_load_dwordx4 v[248:251], v144, s[98:99] offset:2048 nt
    s_waitcnt vmcnt(4)
    global_load_dwordx4 v[252:255], v144, s[98:99] offset:3072 nt
    s_add_u32 s98, s98, 28672
    s_addc_u32 s99, s99, 0
    s_waitcnt vmcnt(8)
    v_perm_b32 v48, v164, v160, s38
    v_perm_b32 v49, v172, v168, s38
    s_nop 1
    v_mfma_f32_16x16x16_bf16 v[64:67], v[104:105], v[48:49], v[64:67]
    v_perm_b32 v52, v164, v160, s39
    v_perm_b32 v53, v172, v168, s39
    s_nop 1
    v_mfma_f32_16x16x16_bf16 v[68:71], v[104:105], v[52:53], v[68:71]
    v_perm_b32 v56, v165, v161, s38
    v_perm_b32 v57, v173, v169, s38
    s_nop 1
    v_mfma_f32_16x16x16_bf16 v[72:75], v[104:105], v[56:57], v[72:75]
    v_perm_b32 v60, v165, v161, s39
    v_perm_b32 v61, v173, v169, s39
    s_nop 1
    v_mfma_f32_16x16x16_bf16 v[76:79], v[104:105], v[60:61], v[76:79]
    v_perm_b32 v48, v166, v162, s38
    v_perm_b32 v49, v174, v170, s38
    s_nop 1
    v_mfma_f32_16x16x16_bf16 v[80:83], v[104:105], v[48:49], v[80:83]
    v_perm_b32 v52, v166, v162, s39
    v_perm_b32 v53, v174, v170, s39
    s_nop 1
    v_mfma_f32_16x16x16_bf16 v[84:87], v[104:105], v[52:53], v[84:87]
    v_perm_b32 v56, v167, v163, s38
    v_perm_b32 v57, v175, v171, s38
    s_nop 1
    v_mfma_f32_16x16x16_bf16 v[88:91], v[104:105], v[56:57], v[88:91]
    v_perm_b32 v60, v167, v163, s39
    v_perm_b32 v61, v175, v171, s39
    s_nop 1
    v_mfma_f32_16x16x16_bf16 v[92:95], v[104:105], v[60:61], v[92:95]
    s_cmp_lt_u32 s3, s56
    s_cbranch_scc0 L_skip_147
    s_waitcnt vmcnt(8)
    v_perm_b32 v48, v180, v176, s38
    v_perm_b32 v49, v188, v184, s38
    s_nop 1
    v_mfma_f32_16x16x16_bf16 v[64:67], v[106:107], v[48:49], v[64:67]
    v_perm_b32 v52, v180, v176, s39
    v_perm_b32 v53, v188, v184, s39
    s_nop 1
    v_mfma_f32_16x16x16_bf16 v[68:71], v[106:107], v[52:53], v[68:71]
    v_perm_b32 v56, v181, v177, s38
    v_perm_b32 v57, v189, v185, s38
    s_nop 1
    v_mfma_f32_16x16x16_bf16 v[72:75], v[106:107], v[56:57], v[72:75]
    v_perm_b32 v60, v181, v177, s39
    v_perm_b32 v61, v189, v185, s39
    s_nop 1
    v_mfma_f32_16x16x16_bf16 v[76:79], v[106:107], v[60:61], v[76:79]
    v_perm_b32 v48, v182, v178, s38
    v_perm_b32 v49, v190, v186, s38
    s_nop 1
    v_mfma_f32_16x16x16_bf16 v[80:83], v[106:107], v[48:49], v[80:83]
    v_perm_b32 v52, v182, v178, s39
    v_perm_b32 v53, v190, v186, s39
    s_nop 1
    v_mfma_f32_16x16x16_bf16 v[84:87], v[106:107], v[52:53], v[84:87]
    v_perm_b32 v56, v183, v179, s38
    v_perm_b32 v57, v191, v187, s38
    s_nop 1
    v_mfma_f32_16x16x16_bf16 v[88:91], v[106:107], v[56:57], v[88:91]
    v_perm_b32 v60, v183, v179, s39
    v_perm_b32 v61, v191, v187, s39
    s_nop 1
    v_mfma_f32_16x16x16_bf16 v[92:95], v[106:107], v[60:61], v[92:95]
L_skip_147:
    v_mul_f32 v20, v99, v64
    v_mul_f32 v21, v99, v68
    v_mul_f32 v22, v99, v72
    v_mul_f32 v23, v99, v76
    v_mul_f32 v24, v99, v80
    v_mul_f32 v25, v99, v84
    v_mul_f32 v26, v99, v88
    s_nop 0
    v_mul_f32 v27, v99, v92
    ds_write_b128 v96, v[20:23] offset:10240
    ds_write_b128 v96, v[24:27] offset:10256
    s_waitcnt lgkmcnt(0)
    s_barrier
    s_cmp_ge_u32 s3, 6
    s_cbranch_scc0 L_skip_148
    ds_read_b128 v[20:23], v16 offset:10240
    ds_read_b128 v[24:27], v16 offset:12288
    ds_read_b128 v[28:31], v16 offset:14336
    ds_read_b128 v[32:35], v16 offset:16384
    ds_read_b128 v[36:39], v16 offset:18432
    ds_read_b128 v[40:43], v16 offset:20480
    ds_read_b128 v[44:47], v16 offset:22528
    ds_read_b128 v[48:51], v16 offset:24576
    s_waitcnt lgkmcnt(0)
    v_add_f32 v20, v20, v36
    v_add_f32 v21, v21, v37
    v_add_f32 v22, v22, v38
    v_add_f32 v23, v23, v39
    v_add_f32 v24, v24, v40
    v_add_f32 v25, v25, v41
    v_add_f32 v26, v26, v42
    v_add_f32 v27, v27, v43
    v_add_f32 v28, v28, v44
    v_add_f32 v29, v29, v45
    v_add_f32 v30, v30, v46
    v_add_f32 v31, v31, v47
    v_add_f32 v32, v32, v48
    v_add_f32 v33, v33, v49
    v_add_f32 v34, v34, v50
    v_add_f32 v35, v35, v51
    v_add_f32 v20, v20, v28
    v_add_f32 v21, v21, v29
    v_add_f32 v22, v22, v30
    v_add_f32 v23, v23, v31
    v_add_f32 v24, v24, v32
    v_add_f32 v25, v25, v33
    v_add_f32 v26, v26, v34
    v_add_f32 v27, v27, v35
    v_add_f32 v20, v20, v24
    v_add_f32 v21, v21, v25
    v_add_f32 v22, v22, v26
    v_add_f32 v23, v23, v27
    v_perm_b32 v20, v20, v3, s34
    v_perm_b32 v21, v21, v3, s35
    v_perm_b32 v22, v22, v3, s36
    v_perm_b32 v23, v23, v3, s37
    s_cmp_lg_u32 s90, 0
    s_cbranch_scc1 L_sl_149
    global_store_dwordx4 v98, v[20:23], s[40:41] sc1
    s_branch L_sd_150
L_sl_149:
    global_store_dwordx4 v98, v[20:23], s[40:41]
L_sd_150:
L_skip_148:
    s_waitcnt vmcnt(4)
    global_load_dwordx4 v[192:195], v144, s[98:99] offset:0 nt
    s_waitcnt vmcnt(4)
    global_load_dwordx4 v[196:199], v144, s[98:99] offset:1024 nt
    s_waitcnt vmcnt(4)
    global_load_dwordx4 v[200:203], v144, s[98:99] offset:2048 nt
    s_waitcnt vmcnt(4)
    global_load_dwordx4 v[204:207], v144, s[98:99] offset:3072 nt
    s_add_u32 s98, s98, 4096
    s_addc_u32 s99, s99, 0
    s_waitcnt vmcnt(4)
    global_load_dwordx4 v[208:211], v144, s[98:99] offset:0 nt
    s_waitcnt vmcnt(4)
    global_load_dwordx4 v[212:215], v144, s[98:99] offset:1024 nt
    s_waitcnt vmcnt(4)
    global_load_dwordx4 v[216:219], v144, s[98:99] offset:2048 nt
    s_waitcnt vmcnt(4)
    global_load_dwordx4 v[220:223], v144, s[98:99] offset:3072 nt
    s_add_u32 s98, s98, 28672
    s_addc_u32 s99, s99, 0
    v_mov_b32 v4, 0
    v_mov_b32 v5, 0
    v_mov_b32 v6, 0
    v_mov_b32 v7, 0
    v_mov_b32 v8, 29696
    ds_write_b128 v8, v[4:7]
    s_waitcnt vmcnt(8)
    v_perm_b32 v8, v228, v224, s38
    v_perm_b32 v9, v236, v232, s38
    v_perm_b32 v10, v244, v240, s38
    v_perm_b32 v11, v252, v248, s38
    ds_write_b128 v145, v[8:11] offset:0
    v_perm_b32 v12, v228, v224, s39
    v_perm_b32 v13, v236, v232, s39
    v_perm_b32 v14, v244, v240, s39
    v_perm_b32 v15, v252, v248, s39
    ds_write_b128 v145, v[12:15] offset:1024
    v_perm_b32 v16, v229, v225, s38
    v_perm_b32 v17, v237, v233, s38
    v_perm_b32 v18, v245, v241, s38
    v_perm_b32 v19, v253, v249, s38
    ds_write_b128 v145, v[16:19] offset:2048
    v_perm_b32 v20, v229, v225, s39
    v_perm_b32 v21, v237, v233, s39
    v_perm_b32 v22, v245, v241, s39
    v_perm_b32 v23, v253, v249, s39
    ds_write_b128 v145, v[20:23] offset:3072
    v_perm_b32 v8, v230, v226, s38
    v_perm_b32 v9, v238, v234, s38
    v_perm_b32 v10, v246, v242, s38
    v_perm_b32 v11, v254, v250, s38
    ds_write_b128 v145, v[8:11] offset:4096
    v_perm_b32 v12, v230, v226, s39
    v_perm_b32 v13, v238, v234, s39
    v_perm_b32 v14, v246, v242, s39
    v_perm_b32 v15, v254, v250, s39
    ds_write_b128 v145, v[12:15] offset:5120
    v_perm_b32 v16, v231, v227, s38
    v_perm_b32 v17, v239, v235, s38
    v_perm_b32 v18, v247, v243, s38
    v_perm_b32 v19, v255, v251, s38
    ds_write_b128 v145, v[16:19] offset:6144
    v_perm_b32 v20, v231, v227, s39
    v_perm_b32 v21, v239, v235, s39
    v_perm_b32 v22, v247, v243, s39
    v_perm_b32 v23, v255, v251, s39
    ds_write_b128 v145, v[20:23] offset:7168
    s_waitcnt vmcnt(0)
    v_perm_b32 v8, v196, v192, s38
    v_perm_b32 v9, v204, v200, s38
    v_perm_b32 v10, v212, v208, s38
    v_perm_b32 v11, v220, v216, s38
    ds_write_b128 v145, v[8:11] offset:8192
    v_perm_b32 v12, v196, v192, s39
    v_perm_b32 v13, v204, v200, s39
    v_perm_b32 v14, v212, v208, s39
    v_perm_b32 v15, v220, v216, s39
    ds_write_b128 v145, v[12:15] offset:9216
    v_perm_b32 v16, v197, v193, s38
    v_perm_b32 v17, v205, v201, s38
    v_perm_b32 v18, v213, v209, s38
    v_perm_b32 v19, v221, v217, s38
    ds_write_b128 v145, v[16:19] offset:10240
    v_perm_b32 v20, v197, v193, s39
    v_perm_b32 v21, v205, v201, s39
    v_perm_b32 v22, v213, v209, s39
    v_perm_b32 v23, v221, v217, s39
    ds_write_b128 v145, v[20:23] offset:11264
    v_perm_b32 v8, v198, v194, s38
    v_perm_b32 v9, v206, v202, s38
    v_perm_b32 v10, v214, v210, s38
    v_perm_b32 v11, v222, v218, s38
    ds_write_b128 v145, v[8:11] offset:12288
    v_perm_b32 v12, v198, v194, s39
    v_perm_b32 v13, v206, v202, s39
    v_perm_b32 v14, v214, v210, s39
    v_perm_b32 v15, v222, v218, s39
    ds_write_b128 v145, v[12:15] offset:13312
    v_perm_b32 v16, v199, v195, s38
    v_perm_b32 v17, v207, v203, s38
    v_perm_b32 v18, v215, v211, s38
    v_perm_b32 v19, v223, v219, s38
    ds_write_b128 v145, v[16:19] offset:14336
    v_perm_b32 v20, v199, v195, s39
    v_perm_b32 v21, v207, v203, s39
    v_perm_b32 v22, v215, v211, s39
    v_perm_b32 v23, v223, v219, s39
    ds_write_b128 v145, v[20:23] offset:15360
    s_waitcnt lgkmcnt(0)
    s_barrier
    s_cmp_ge_u32 s3, 4
    s_cbranch_scc1 L_fin
    s_lshl_b32 s62, s3, 15
    s_add_u32 s62, s62, 32768
    v_lshlrev_b32 v31, 4, v0
    v_add_u32 v30, s62, v31
    ds_read_b128 v[32:35], v30 offset:0
    ds_read_b128 v[36:39], v30 offset:1024
    ds_read_b128 v[40:43], v30 offset:2048
    ds_read_b128 v[44:47], v30 offset:3072
    ds_read_b128 v[48:51], v30 offset:4096
    ds_read_b128 v[52:55], v30 offset:5120
    ds_read_b128 v[56:59], v30 offset:6144
    ds_read_b128 v[60:63], v30 offset:7168
    ds_read_b128 v[64:67], v30 offset:8192
    ds_read_b128 v[68:71], v30 offset:9216
    ds_read_b128 v[72:75], v30 offset:10240
    ds_read_b128 v[76:79], v30 offset:11264
    ds_read_b128 v[80:83], v30 offset:12288
    ds_read_b128 v[84:87], v30 offset:13312
    ds_read_b128 v[88:91], v30 offset:14336
    ds_read_b128 v[92:95], v30 offset:15360
    ds_read_b128 v[96:99], v30 offset:16384
    ds_read_b128 v[100:103], v30 offset:17408
    ds_read_b128 v[104:107], v30 offset:18432
    ds_read_b128 v[108:111], v30 offset:19456
    ds_read_b128 v[112:115], v30 offset:20480
    ds_read_b128 v[116:119], v30 offset:21504
    ds_read_b128 v[120:123], v30 offset:22528
    ds_read_b128 v[124:127], v30 offset:23552
    ds_read_b128 v[128:131], v30 offset:24576
    ds_read_b128 v[132:135], v30 offset:25600
    ds_read_b128 v[136:139], v30 offset:26624
    ds_read_b128 v[140:143], v30 offset:27648
    ds_read_b128 v[144:147], v30 offset:28672
    ds_read_b128 v[148:151], v30 offset:29696
    ds_read_b128 v[152:155], v30 offset:30720
    ds_read_b128 v[156:159], v30 offset:31744
    s_and_b32 s2, s2, 31
    s_add_u32 s3, s3, 4
    s_branch L_ldok
L_fin:
L_end:
    s_endpgm
.p2align 2
.type L_tiles,@object
L_tiles:
.long 0x380000
.long 0x1380000
.long 0x2380000
.long 0x3380000
.long 0x4380000
.long 0x5380000
.long 0x6380000
.long 0x7380000
.long 0x10380033
.long 0x11380033
.long 0x12380033
.long 0x13380033
.long 0x14380033
.long 0x15380033
.long 0x16380033
.long 0x17380033
.long 0x8380000
.long 0x9380000
.long 0xa380000
.long 0xb380000
.long 0xc380000
.long 0xd380000
.long 0xe380000
.long 0xf380000
.long 0x18380033
.long 0x19380033
.long 0x1a380033
.long 0x1b380033
.long 0x1c380033
.long 0x1d380033
.long 0x1e380033
.long 0x1f380033
.long 0x20380066
.long 0x21380066
.long 0x22380066
.long 0x23380066
.long 0x24380066
.long 0x25380066
.long 0x26380066
.long 0x27380066
.long 0x30380099
.long 0x31380099
.long 0x32380099
.long 0x33380099
.long 0x34380099
.long 0x35380099
.long 0x36380099
.long 0x37380099
.long 0x28380066
.long 0x29380066
.long 0x2a380066
.long 0x2b380066
.long 0x2c380066
.long 0x2d380066
.long 0x2e380066
.long 0x2f380066
.long 0x38380099
.long 0x39380099
.long 0x3a380099
.long 0x3b380099
.long 0x3c380099
.long 0x3d380099
.long 0x3e380099
.long 0x3f380099
.long 0x402800cc
.long 0x412800cc
.long 0x422800cc
.long 0x432800cc
.long 0x442800cc
.long 0x452800cc
.long 0x462800cc
.long 0x472800cc
.long 0x502800fe
.long 0x512800fe
.long 0x522800fe
.long 0x532800fe
.long 0x542800fe
.long 0x552800fe
.long 0x562800fe
.long 0x572800fe
.long 0x482800cc
.long 0x492800cc
.long 0x4a2800cc
.long 0x4b2800cc
.long 0x4c2800cc
.long 0x4d2800cc
.long 0x4e2800cc
.long 0x4f2800cc
.long 0x582800fe
.long 0x592800fe
.long 0x5a2800fe
.long 0x5b2800fe
.long 0x5c2800fe
.long 0x5d2800fe
.long 0x5e2800fe
.long 0x5f2800fe
.long 0x60280130
.long 0x61280130
.long 0x62280130
.long 0x63280130
.long 0x64280130
.long 0x65280130
.long 0x66280130
.long 0x67280130
.long 0x70280162
.long 0x71280162
.long 0x72280162
.long 0x73280162
.long 0x74280162
.long 0x75280162
.long 0x76280162
.long 0x77280162
.long 0x68280130
.long 0x69280130
.long 0x6a280130
.long 0x6b280130
.long 0x6c280130
.long 0x6d280130
.long 0x6e280130
.long 0x6f280130
.long 0x78280162
.long 0x79280162
.long 0x7a280162
.long 0x7b280162
.long 0x7c280162
.long 0x7d280162
.long 0x7e280162
.long 0x7f280162
.long 0x80060194
.long 0x81060194
.long 0x82060194
.long 0x83060194
.long 0x84060194
.long 0x85060194
.long 0x86060194
.long 0x87060194
.long 0x88060194
.long 0x89060194
.long 0x8a060194
.long 0x8b060194
.long 0x8c060194
.long 0x8d060194
.long 0x8e060194
.long 0x8f060194
.long 0x900601b2
.long 0x910601b2
.long 0x920601b2
.long 0x930601b2
.long 0x940601b2
.long 0x950601b2
.long 0x960601b2
.long 0x970601b2
.long 0x980601b2
.long 0x990601b2
.long 0x9a0601b2
.long 0x9b0601b2
.long 0x9c0601b2
.long 0x9d0601b2
.long 0x9e0601b2
.long 0x9f0601b2
.section .rodata,"a"
.p2align 6
.amdhsa_kernel concat_heads__compressed_kv_cla__gqa_block_cached__decode_kernel
  .amdhsa_next_free_vgpr 256
  .amdhsa_next_free_sgpr 102
  .amdhsa_accum_offset 256
  .amdhsa_group_segment_fixed_size 0
  .amdhsa_kernarg_size 112
  .amdhsa_user_sgpr_count 2
  .amdhsa_user_sgpr_kernarg_segment_ptr 1
  .amdhsa_system_sgpr_workgroup_id_x 1
.end_amdhsa_kernel
```
